```python
import torch

def _softmax(x, axis=-1):
    return torch.softmax(x, dim=axis)
def _gelu(x):
    return torch.nn.functional.gelu(x, approximate="tanh")
def _silu(x):
    return torch.nn.functional.silu(x)
def _sigmoid(x):
    return torch.sigmoid(x)
def _layernorm(x, axis=-1, eps=1e-5):
    m = x.mean(dim=axis, keepdim=True)
    v = x.var(dim=axis, keepdim=True, unbiased=False)
    return (x - m) / torch.sqrt(v + eps)
def _scatter_add(tgt, idx, src, axis=0):
    return tgt.clone().index_add_(axis, idx, src)
def _segment_sum(src, seg, n):
    out = torch.zeros((n,) + src.shape[1:], dtype=src.dtype)
    return out.index_add_(0, seg, src)
def _pad(x, pw):
    flat = tuple(v for pair in reversed(pw) for v in pair)
    return torch.nn.functional.pad(x, flat)

kernel_name = 'gated_mix__sliding_block__softmax_full_mha__prompt'

def setup_inputs():

    _w = (lambda a: (lambda t: t.to(torch.bfloat16) if t.is_floating_point() else t)(torch.as_tensor(a)))
    def _A_setup():
        B, S, D = 1, 2048, 512
        return {
            "x": _w((lambda *s: torch.randn(*s, dtype=torch.bfloat16) * 0.05)(B, S, D)),
            "wqkv": _w((lambda *s: torch.randn(*s, dtype=torch.bfloat16) * 1.6)(D, 3 * D)),
            "wo": _w((lambda *s: torch.randn(*s, dtype=torch.bfloat16) * 0.05)(D, D)),
        }
    _A_in = _A_setup()

    def _B_setup():
        B, S, D = 1, 2048, 512
        return {
            "x": _w((lambda *s: torch.randn(*s, dtype=torch.bfloat16) * 0.05)(B, S, D)),
            "wqkv": _w((lambda *s: torch.randn(*s, dtype=torch.bfloat16) * 1.6)(D, 3 * D)),
            "wo": _w((lambda *s: torch.randn(*s, dtype=torch.bfloat16) * 0.1)(D, D)),
        }
    _B_in = _B_setup()

    return {
        "A_x": _A_in["x"],
        "A_wqkv": _A_in["wqkv"],
        "A_wo": _A_in["wo"],
        "B_x": _B_in["x"],
        "B_wqkv": _B_in["wqkv"],
        "B_wo": _B_in["wo"],
        "gate_w": _w((lambda *s: torch.randn(*s, dtype=torch.bfloat16) * 0.05)(512) * 16.0),
    }

def reference(A_x, A_wqkv, A_wo, B_x, B_wqkv, B_wo, gate_w):
    def _A_ref(x, wqkv, wo):
        B, S, D = x.shape
        H = 32; Dh = D // H; W = 256
        qkv = (lambda x, *d: x.permute(*d))((x @ wqkv).reshape(B, S, 3, H, Dh), 2, 0, 3, 1, 4)
        q, k, v = qkv[0], qkv[1], qkv[2]
        scores = torch.einsum("bhqd,bhkd->bhqk", q, k) * (Dh ** -0.5)
        idx = torch.arange(S)
        mask = (idx[:, None] - idx[None, :] >= 0) & (idx[:, None] - idx[None, :] < W)
        scores = torch.where(mask[None, None], scores, -1e9)
        p = _softmax(scores, axis=-1)
        o = torch.einsum("bhqk,bhkd->bhqd", p, v)
        return (lambda x, *d: x.permute(*d))(o, 0, 2, 1, 3).reshape(B, S, D) @ wo

    def _B_ref(x, wqkv, wo):
        B, S, D = x.shape
        H = 32; Dh = D // H
        qkv = (lambda x, *d: x.permute(*d))((x @ wqkv).reshape(B, S, 3, H, Dh), 2, 0, 3, 1, 4)
        q, k, v = qkv[0], qkv[1], qkv[2]
        scale = Dh ** -0.5
        scores = torch.einsum("bhqd,bhkd->bhqk", q, k) * scale
        p = _softmax(scores, axis=-1)
        o = torch.einsum("bhqk,bhkd->bhqd", p, v)
        return (lambda x, *d: x.permute(*d))(o, 0, 2, 1, 3).reshape(B, S, D) @ wo

    x = A_x
    g = _sigmoid((x * gate_w).sum(-1, keepdims=True))
    a = _A_ref(x, A_wqkv, A_wo)
    b = _B_ref(x, B_wqkv, B_wo)
    return g * a + (1 - g) * b
```

```asm
; @launch grid=(256,1,1) block=(512,1,1) lds=163840
.amdgcn_target "amdgcn-amd-amdhsa--gfx950"
.text
.globl gated_mix__sliding_block__softmax_full_mha__prompt_kernel
.p2align 8
.type gated_mix__sliding_block__softmax_full_mha__prompt_kernel,@function
gated_mix__sliding_block__softmax_full_mha__prompt_kernel:
    s_cmp_ge_u32 s2, 256
    s_cbranch_scc1 L_end
    s_load_dwordx2 s[4:5], s[0:1], 0
    s_load_dwordx4 s[12:15], s[0:1], 32
    s_load_dwordx4 s[8:11], s[0:1], 8
    s_load_dwordx2 s[6:7], s[0:1], 48
    s_load_dwordx4 s[16:19], s[0:1], 56
    s_load_dwordx2 s[20:21], s[0:1], 72
    v_lshrrev_b32 v2, 6, v0
    v_and_b32 v1, 63, v0
    s_bfe_u32 s62, s2, 0x20003
    v_readfirstlane_b32 s56, v2
    s_and_b32 s63, s2, 3
    s_lshl_b32 s63, s63, 2
    s_add_u32 s68, s63, s62
    s_lshr_b32 s69, s2, 5
    v_lshlrev_b32 v14, 4, v1
    s_cmp_lt_u32 s56, 4
    s_cbranch_scc1 L_compute
    s_sub_u32 s66, s56, 4
    v_lshrrev_b32 v2, 3, v1
    v_and_b32 v3, 7, v1
    v_lshrrev_b32 v4, 4, v1
    v_xor_b32 v5, v3, v4
    v_lshlrev_b32 v5, 4, v5
    v_lshl_add_u32 v6, v2, 10, v5
    s_lshl_b32 s63, s68, 17
    s_lshl_b32 s64, s66, 15
    s_add_u32 s63, s63, s64
    v_add_u32 v16, s63, v6
    v_xor_b32 v17, 64, v16
    v_add_u32 v17, 8192, v17
    v_add_u32 v18, 16384, v16
    v_add_u32 v19, 16384, v17
    s_add_u32 s3, s62, s69
    s_and_b32 s3, s3, 3
    s_lshl_b32 s3, s3, 1
    s_lshl_b32 s67, s66, 12
    s_add_u32 s67, s67, 32768
    s_mov_b32 s26, 0x200000
    s_mov_b32 s27, 0x20000
    s_lshl_b32 s62, s3, 7
    s_waitcnt lgkmcnt(0)
    s_mov_b32 s24, s4
    s_and_b32 s25, s5, 0xffff
    s_add_u32 m0, s67, 0
    s_nop 0
    buffer_load_dwordx4 v16, s[24:27], s62 offen lds
    s_add_u32 m0, s67, 1024
    s_nop 0
    buffer_load_dwordx4 v17, s[24:27], s62 offen lds
    s_add_u32 m0, s67, 2048
    s_nop 0
    buffer_load_dwordx4 v18, s[24:27], s62 offen lds
    s_add_u32 m0, s67, 3072
    s_nop 0
    buffer_load_dwordx4 v19, s[24:27], s62 offen lds
    v_and_b32 v5, 1, v4
    v_lshlrev_b32 v5, 2, v5
    v_xor_b32 v5, v3, v5
    v_lshlrev_b32 v5, 4, v5
    v_mul_u32_u24 v8, 3072, v2
    s_mul_i32 s63, s66, 49152
    v_add3_u32 v20, v8, v5, s63
    v_add_u32 v21, 24576, v20
    s_lshr_b32 s64, s69, 1
    s_xor_b32 s64, s64, s2
    s_and_b32 s64, s64, 1
    s_lshl_b32 s64, s64, 1
    s_and_b32 s65, s69, 1
    s_add_u32 s65, s65, s64
    s_xor_b32 s64, s65, 2
    s_and_b32 s22, s69, 3
    s_add_u32 s23, s69, 1
    s_and_b32 s23, s23, 3
    s_cmp_lt_u32 s69, 4
    s_cselect_b32 s64, s64, s22
    s_cselect_b32 s65, s65, s23
    s_and_b32 s22, s2, 4
    s_add_u32 s64, s64, s22
    s_add_u32 s65, s65, s22
    s_lshl_b32 s64, s64, 7
    s_lshl_b32 s65, s65, 7
    s_add_u32 s65, s65, 2048
    s_cmp_lt_u32 s69, 4
    s_cselect_b32 s22, 1024, 0
    s_add_u32 s64, s64, s22
    s_cmp_lt_u32 s69, 2
    s_cselect_b32 s22, s65, s64
    s_cselect_b32 s71, s64, s65
    s_lshl_b32 s23, s66, 11
    s_add_u32 s23, s23, 32768
    s_mov_b32 s28, s12
    s_and_b32 s29, s13, 0xffff
    s_mov_b32 s30, 0x180000
    s_mov_b32 s31, 0x20000
    s_lshl_b32 s64, s66, 8
    s_lshl_b32 s65, s3, 7
    s_add_u32 s65, s65, s64
    s_add_u32 s63, s3, 0
    s_and_b32 s63, s63, 7
    s_mul_i32 s63, s63, 196608
    s_add_u32 s63, s63, s22
    s_add_u32 m0, s23, 16384
    s_nop 0
    buffer_load_dwordx4 v20, s[28:31], s63 offen lds
    s_add_u32 m0, s23, 17408
    s_nop 0
    buffer_load_dwordx4 v21, s[28:31], s63 offen lds
    v_lshlrev_b32 v24, 2, v1
    v_add_u32 v24, s65, v24
    v_and_b32 v24, 0x3ff, v24
    s_mov_b32 s52, s6
    s_and_b32 s53, s7, 0xffff
    s_mov_b32 s54, 0x400
    s_mov_b32 s55, 0x20000
    s_add_u32 m0, s64, 28672
    s_nop 0
    buffer_load_dword v24, s[52:55], 0 offen lds
    s_add_u32 s62, s3, 1
    s_and_b32 s62, s62, 7
    s_lshl_b32 s62, s62, 7
    s_add_u32 m0, s67, 32768
    s_nop 0
    buffer_load_dwordx4 v16, s[24:27], s62 offen lds
    s_add_u32 m0, s67, 33792
    s_nop 0
    buffer_load_dwordx4 v17, s[24:27], s62 offen lds
    s_add_u32 m0, s67, 34816
    s_nop 0
    buffer_load_dwordx4 v18, s[24:27], s62 offen lds
    s_add_u32 m0, s67, 35840
    s_nop 0
    buffer_load_dwordx4 v19, s[24:27], s62 offen lds
    s_add_u32 s63, s3, 1
    s_and_b32 s63, s63, 7
    s_mul_i32 s63, s63, 196608
    s_add_u32 s63, s63, s22
    s_add_u32 m0, s23, 49152
    s_nop 0
    buffer_load_dwordx4 v20, s[28:31], s63 offen lds
    s_add_u32 m0, s23, 50176
    s_nop 0
    buffer_load_dwordx4 v21, s[28:31], s63 offen lds
    s_mov_b32 s32, s8
    s_and_b32 s33, s9, 0xffff
    s_mov_b32 s34, 0x180000
    s_mov_b32 s35, 0x20000
    s_xor_b32 s65, s69, 2
    s_and_b32 s65, s65, 3
    s_and_b32 s62, s2, 4
    s_add_u32 s65, s65, s62
    s_lshl_b32 s65, s65, 7
    s_and_b32 s62, s69, 4
    s_lshl_b32 s62, s62, 8
    s_add_u32 s65, s65, s62
    s_cmp_lt_u32 s69, 4
    s_cselect_b32 s40, s28, s32
    s_cselect_b32 s41, s29, s33
    s_mov_b32 s42, 0x180000
    s_mov_b32 s43, 0x20000
    s_add_u32 s63, s3, 0
    s_and_b32 s63, s63, 7
    s_mul_i32 s63, s63, 196608
    s_add_u32 s63, s63, s71
    s_add_u32 m0, s23, 24576
    s_nop 0
    buffer_load_dwordx4 v20, s[40:43], s63 offen lds
    s_add_u32 m0, s23, 25600
    s_nop 0
    buffer_load_dwordx4 v21, s[40:43], s63 offen lds
    s_add_u32 s63, s3, 1
    s_and_b32 s63, s63, 7
    s_mul_i32 s63, s63, 196608
    s_add_u32 s63, s63, s71
    s_add_u32 m0, s23, 122880
    s_nop 0
    buffer_load_dwordx4 v20, s[40:43], s63 offen lds
    s_add_u32 m0, s23, 123904
    s_nop 0
    buffer_load_dwordx4 v21, s[40:43], s63 offen lds
    s_mov_b32 s36, s20
    s_and_b32 s37, s21, 0xffff
    s_mov_b32 s38, 0x1200000
    s_mov_b32 s39, 0x20000
    s_mov_b32 s44, s16
    s_and_b32 s45, s17, 0xffff
    s_mov_b32 s46, 0x200000
    s_mov_b32 s47, 0x20000
    s_mov_b32 s48, s18
    s_and_b32 s49, s19, 0xffff
    s_mov_b32 s50, 0x100
    s_mov_b32 s51, 0x20000
    s_mov_b32 s52, s14
    s_and_b32 s53, s15, 0xffff
    s_mov_b32 s54, 0x80000
    s_mov_b32 s55, 0x20000
    s_mov_b32 s17, s22
    s_mov_b32 s18, s23
    s_lshl_b32 s57, s68, 1
    s_and_b32 s62, s69, 1
    s_add_u32 s57, s57, s62
    s_and_b32 s58, s2, 4
    s_lshr_b32 s62, s69, 1
    s_add_u32 s58, s58, s62
    s_and_b32 s59, s2, 7
    s_lshl_b32 s59, s59, 2
    s_bfe_u32 s62, s2, 0x20003
    s_add_u32 s59, s59, s62
    s_mov_b32 s60, s69
    s_lshl_b32 s61, s60, 3
    s_add_u32 s61, s61, s56
    s_waitcnt vmcnt(10)
    s_barrier
    s_add_u32 s62, s3, 2
    s_and_b32 s62, s62, 7
    s_lshl_b32 s62, s62, 7
    s_add_u32 m0, s67, 65536
    s_nop 0
    buffer_load_dwordx4 v16, s[24:27], s62 offen lds
    s_add_u32 m0, s67, 66560
    s_nop 0
    buffer_load_dwordx4 v17, s[24:27], s62 offen lds
    s_add_u32 m0, s67, 67584
    s_nop 0
    buffer_load_dwordx4 v18, s[24:27], s62 offen lds
    s_add_u32 m0, s67, 68608
    s_nop 0
    buffer_load_dwordx4 v19, s[24:27], s62 offen lds
    s_add_u32 s63, s3, 2
    s_and_b32 s63, s63, 7
    s_mul_i32 s63, s63, 196608
    s_add_u32 s63, s63, s17
    s_add_u32 m0, s18, 81920
    s_nop 0
    buffer_load_dwordx4 v20, s[28:31], s63 offen lds
    s_add_u32 m0, s18, 82944
    s_nop 0
    buffer_load_dwordx4 v21, s[28:31], s63 offen lds
    s_add_u32 s62, s3, 3
    s_and_b32 s62, s62, 7
    s_lshl_b32 s62, s62, 7
    s_add_u32 m0, s67, 98304
    s_nop 0
    buffer_load_dwordx4 v16, s[24:27], s62 offen lds
    s_add_u32 m0, s67, 99328
    s_nop 0
    buffer_load_dwordx4 v17, s[24:27], s62 offen lds
    s_add_u32 m0, s67, 100352
    s_nop 0
    buffer_load_dwordx4 v18, s[24:27], s62 offen lds
    s_add_u32 m0, s67, 101376
    s_nop 0
    buffer_load_dwordx4 v19, s[24:27], s62 offen lds
    s_add_u32 s63, s3, 3
    s_and_b32 s63, s63, 7
    s_mul_i32 s63, s63, 196608
    s_add_u32 s63, s63, s17
    s_add_u32 m0, s18, 114688
    s_nop 0
    buffer_load_dwordx4 v20, s[28:31], s63 offen lds
    s_add_u32 m0, s18, 115712
    s_nop 0
    buffer_load_dwordx4 v21, s[28:31], s63 offen lds
    s_waitcnt vmcnt(16)
    s_barrier
    s_add_u32 s62, s3, 4
    s_and_b32 s62, s62, 7
    s_lshl_b32 s62, s62, 7
    s_add_u32 m0, s67, 0
    s_nop 0
    buffer_load_dwordx4 v16, s[24:27], s62 offen lds
    s_add_u32 m0, s67, 1024
    s_nop 0
    buffer_load_dwordx4 v17, s[24:27], s62 offen lds
    s_add_u32 m0, s67, 2048
    s_nop 0
    buffer_load_dwordx4 v18, s[24:27], s62 offen lds
    s_add_u32 m0, s67, 3072
    s_nop 0
    buffer_load_dwordx4 v19, s[24:27], s62 offen lds
    s_add_u32 s63, s3, 4
    s_and_b32 s63, s63, 7
    s_mul_i32 s63, s63, 196608
    s_add_u32 s63, s63, s17
    s_add_u32 m0, s18, 16384
    s_nop 0
    buffer_load_dwordx4 v20, s[28:31], s63 offen lds
    s_add_u32 m0, s18, 17408
    s_nop 0
    buffer_load_dwordx4 v21, s[28:31], s63 offen lds
    s_waitcnt vmcnt(12)
    s_barrier
    s_add_u32 s62, s3, 5
    s_and_b32 s62, s62, 7
    s_lshl_b32 s62, s62, 7
    s_add_u32 m0, s67, 32768
    s_nop 0
    buffer_load_dwordx4 v16, s[24:27], s62 offen lds
    s_add_u32 m0, s67, 33792
    s_nop 0
    buffer_load_dwordx4 v17, s[24:27], s62 offen lds
    s_add_u32 m0, s67, 34816
    s_nop 0
    buffer_load_dwordx4 v18, s[24:27], s62 offen lds
    s_add_u32 m0, s67, 35840
    s_nop 0
    buffer_load_dwordx4 v19, s[24:27], s62 offen lds
    s_add_u32 s63, s3, 5
    s_and_b32 s63, s63, 7
    s_mul_i32 s63, s63, 196608
    s_add_u32 s63, s63, s17
    s_add_u32 m0, s18, 49152
    s_nop 0
    buffer_load_dwordx4 v20, s[28:31], s63 offen lds
    s_add_u32 m0, s18, 50176
    s_nop 0
    buffer_load_dwordx4 v21, s[28:31], s63 offen lds
    s_waitcnt vmcnt(12)
    s_barrier
    s_add_u32 s62, s3, 6
    s_and_b32 s62, s62, 7
    s_lshl_b32 s62, s62, 7
    s_add_u32 m0, s67, 65536
    s_nop 0
    buffer_load_dwordx4 v16, s[24:27], s62 offen lds
    s_add_u32 m0, s67, 66560
    s_nop 0
    buffer_load_dwordx4 v17, s[24:27], s62 offen lds
    s_add_u32 m0, s67, 67584
    s_nop 0
    buffer_load_dwordx4 v18, s[24:27], s62 offen lds
    s_add_u32 m0, s67, 68608
    s_nop 0
    buffer_load_dwordx4 v19, s[24:27], s62 offen lds
    s_add_u32 s63, s3, 6
    s_and_b32 s63, s63, 7
    s_mul_i32 s63, s63, 196608
    s_add_u32 s63, s63, s17
    s_add_u32 m0, s18, 81920
    s_nop 0
    buffer_load_dwordx4 v20, s[28:31], s63 offen lds
    s_add_u32 m0, s18, 82944
    s_nop 0
    buffer_load_dwordx4 v21, s[28:31], s63 offen lds
    s_waitcnt vmcnt(12)
    s_barrier
    s_add_u32 s62, s3, 7
    s_and_b32 s62, s62, 7
    s_lshl_b32 s62, s62, 7
    s_add_u32 m0, s67, 98304
    s_nop 0
    buffer_load_dwordx4 v16, s[24:27], s62 offen lds
    s_add_u32 m0, s67, 99328
    s_nop 0
    buffer_load_dwordx4 v17, s[24:27], s62 offen lds
    s_add_u32 m0, s67, 100352
    s_nop 0
    buffer_load_dwordx4 v18, s[24:27], s62 offen lds
    s_add_u32 m0, s67, 101376
    s_nop 0
    buffer_load_dwordx4 v19, s[24:27], s62 offen lds
    s_add_u32 s63, s3, 7
    s_and_b32 s63, s63, 7
    s_mul_i32 s63, s63, 196608
    s_add_u32 s63, s63, s17
    s_add_u32 m0, s18, 114688
    s_nop 0
    buffer_load_dwordx4 v20, s[28:31], s63 offen lds
    s_add_u32 m0, s18, 115712
    s_nop 0
    buffer_load_dwordx4 v21, s[28:31], s63 offen lds
    s_waitcnt vmcnt(12)
    s_barrier
    s_add_u32 s63, s3, 2
    s_and_b32 s63, s63, 7
    s_mul_i32 s63, s63, 196608
    s_add_u32 s63, s63, s71
    s_add_u32 m0, s18, 0
    s_nop 0
    buffer_load_dwordx4 v20, s[40:43], s63 offen lds
    s_add_u32 m0, s18, 1024
    s_nop 0
    buffer_load_dwordx4 v21, s[40:43], s63 offen lds
    s_add_u32 s63, s3, 3
    s_and_b32 s63, s63, 7
    s_mul_i32 s63, s63, 196608
    s_add_u32 s63, s63, s71
    s_add_u32 m0, s18, 8192
    s_nop 0
    buffer_load_dwordx4 v20, s[40:43], s63 offen lds
    s_add_u32 m0, s18, 9216
    s_nop 0
    buffer_load_dwordx4 v21, s[40:43], s63 offen lds
    s_waitcnt vmcnt(10)
    s_barrier
    s_add_u32 s63, s3, 4
    s_and_b32 s63, s63, 7
    s_mul_i32 s63, s63, 196608
    s_add_u32 s63, s63, s71
    s_add_u32 m0, s18, 16384
    s_nop 0
    buffer_load_dwordx4 v20, s[40:43], s63 offen lds
    s_add_u32 m0, s18, 17408
    s_nop 0
    buffer_load_dwordx4 v21, s[40:43], s63 offen lds
    s_add_u32 s63, s3, 5
    s_and_b32 s63, s63, 7
    s_mul_i32 s63, s63, 196608
    s_add_u32 s63, s63, s71
    s_add_u32 m0, s18, 32768
    s_nop 0
    buffer_load_dwordx4 v20, s[40:43], s63 offen lds
    s_add_u32 m0, s18, 33792
    s_nop 0
    buffer_load_dwordx4 v21, s[40:43], s63 offen lds
    s_add_u32 s63, s3, 6
    s_and_b32 s63, s63, 7
    s_mul_i32 s63, s63, 196608
    s_add_u32 s63, s63, s71
    s_add_u32 m0, s18, 40960
    s_nop 0
    buffer_load_dwordx4 v20, s[40:43], s63 offen lds
    s_add_u32 m0, s18, 41984
    s_nop 0
    buffer_load_dwordx4 v21, s[40:43], s63 offen lds
    s_add_u32 s63, s3, 7
    s_and_b32 s63, s63, 7
    s_mul_i32 s63, s63, 196608
    s_add_u32 s63, s63, s71
    s_add_u32 m0, s18, 49152
    s_nop 0
    buffer_load_dwordx4 v20, s[40:43], s63 offen lds
    s_add_u32 m0, s18, 50176
    s_nop 0
    buffer_load_dwordx4 v21, s[40:43], s63 offen lds
    s_waitcnt vmcnt(12)
    s_barrier
    s_add_u32 s63, s3, 0
    s_and_b32 s63, s63, 7
    s_mul_i32 s63, s63, 196608
    s_add_u32 s63, s63, s65
    s_add_u32 m0, s18, 57344
    s_nop 0
    buffer_load_dwordx4 v20, s[32:35], s63 offen lds
    s_add_u32 m0, s18, 58368
    s_nop 0
    buffer_load_dwordx4 v21, s[32:35], s63 offen lds
    s_add_u32 s63, s3, 1
    s_and_b32 s63, s63, 7
    s_mul_i32 s63, s63, 196608
    s_add_u32 s63, s63, s65
    s_add_u32 m0, s18, 90112
    s_nop 0
    buffer_load_dwordx4 v20, s[32:35], s63 offen lds
    s_add_u32 m0, s18, 91136
    s_nop 0
    buffer_load_dwordx4 v21, s[32:35], s63 offen lds
    s_waitcnt vmcnt(52)
    s_barrier
    s_waitcnt vmcnt(12)
    s_barrier
    s_waitcnt vmcnt(4)
    s_barrier
    s_add_u32 s63, s3, 2
    s_and_b32 s63, s63, 7
    s_mul_i32 s63, s63, 196608
    s_add_u32 s63, s63, s65
    s_add_u32 m0, s18, 65536
    s_nop 0
    buffer_load_dwordx4 v20, s[32:35], s63 offen lds
    s_add_u32 m0, s18, 66560
    s_nop 0
    buffer_load_dwordx4 v21, s[32:35], s63 offen lds
    s_add_u32 s63, s3, 3
    s_and_b32 s63, s63, 7
    s_mul_i32 s63, s63, 196608
    s_add_u32 s63, s63, s65
    s_add_u32 m0, s18, 73728
    s_nop 0
    buffer_load_dwordx4 v20, s[32:35], s63 offen lds
    s_add_u32 m0, s18, 74752
    s_nop 0
    buffer_load_dwordx4 v21, s[32:35], s63 offen lds
    s_add_u32 s63, s3, 4
    s_and_b32 s63, s63, 7
    s_mul_i32 s63, s63, 196608
    s_add_u32 s63, s63, s65
    s_add_u32 m0, s18, 81920
    s_nop 0
    buffer_load_dwordx4 v20, s[32:35], s63 offen lds
    s_add_u32 m0, s18, 82944
    s_nop 0
    buffer_load_dwordx4 v21, s[32:35], s63 offen lds
    s_add_u32 s63, s3, 5
    s_and_b32 s63, s63, 7
    s_mul_i32 s63, s63, 196608
    s_add_u32 s63, s63, s65
    s_add_u32 m0, s18, 98304
    s_nop 0
    buffer_load_dwordx4 v20, s[32:35], s63 offen lds
    s_add_u32 m0, s18, 99328
    s_nop 0
    buffer_load_dwordx4 v21, s[32:35], s63 offen lds
    s_and_b32 s62, s69, 1
    s_lshl_b32 s62, s62, 1
    s_and_b32 s63, s56, 1
    s_add_u32 s62, s62, s63
    s_lshl_b32 s62, s62, 7
    s_add_u32 s62, s62, 29696
    v_and_b32 v3, 31, v1
    v_lshl_add_u32 v3, v3, 2, s62
    ds_read_b32 v112, v3
    s_waitcnt lgkmcnt(0)
    s_waitcnt vmcnt(8)
    s_barrier
    s_add_u32 s63, s3, 6
    s_and_b32 s63, s63, 7
    s_mul_i32 s63, s63, 196608
    s_add_u32 s63, s63, s65
    s_add_u32 m0, s18, 106496
    s_nop 0
    buffer_load_dwordx4 v20, s[32:35], s63 offen lds
    s_add_u32 m0, s18, 107520
    s_nop 0
    buffer_load_dwordx4 v21, s[32:35], s63 offen lds
    s_add_u32 s63, s3, 7
    s_and_b32 s63, s63, 7
    s_mul_i32 s63, s63, 196608
    s_add_u32 s63, s63, s65
    s_add_u32 m0, s18, 114688
    s_nop 0
    buffer_load_dwordx4 v20, s[32:35], s63 offen lds
    s_add_u32 m0, s18, 115712
    s_nop 0
    buffer_load_dwordx4 v21, s[32:35], s63 offen lds
    s_mov_b32 s40, s10
    s_and_b32 s41, s11, 0xffff
    s_mov_b32 s42, 0x80000
    s_mov_b32 s43, 0x20000
    s_lshl_b32 s20, s57, 17
    s_and_b32 s4, s56, 1
    s_lshl_b32 s4, s4, 16
    s_add_u32 s20, s20, s4
    s_lshr_b32 s4, s56, 1
    s_lshl_b32 s4, s4, 13
    s_add_u32 s20, s20, s4
    s_add_u32 s20, s20, 0xc00000
    v_lshrrev_b32 v116, 5, v1
    v_bfe_u32 v117, v1, 2, 2
    v_lshl_add_u32 v8, v116, 2, v117
    v_lshlrev_b32 v8, 7, v8
    v_bfe_u32 v116, v1, 4, 1
    v_lshlrev_b32 v116, 1, v116
    v_bfe_u32 v117, v1, 1, 1
    v_add_u32 v116, v116, v117
    v_bfe_u32 v117, v1, 3, 1
    v_lshl_or_b32 v116, v117, 2, v116
    v_lshl_add_u32 v8, v116, 4, v8
    v_and_b32 v116, 1, v1
    v_lshl_add_u32 v8, v116, 3, v8
    s_lshr_b32 s4, s56, 1
    s_lshl_b32 s4, s4, 14
    s_add_u32 s4, s4, 65536
    v_add_u32 v8, s4, v8
    v_xor_b32 v9, 64, v8
    s_lshr_b32 s4, s56, 1
    s_mul_i32 s4, s4, 17408
    s_and_b32 s5, s56, 1
    s_mul_i32 s5, s5, 8704
    s_add_u32 s4, s4, s5
    s_add_u32 s4, s4, 65536
    v_add_u32 v2, s4, v14
    v_and_b32 v116, 7, v1
    v_lshrrev_b32 v117, 3, v1
    s_and_b32 s4, s56, 3
    s_lshl_b32 s4, s4, 3
    v_add_u32 v117, s4, v117
    v_mul_u32_u24 v7, 1088, v116
    v_lshl_add_u32 v7, v117, 4, v7
    s_lshr_b32 s4, s56, 2
    s_mul_i32 s5, s4, 8704
    s_add_u32 s5, s5, 65536
    v_add_u32 v7, s5, v7
    v_lshlrev_b32 v6, 10, v117
    v_lshl_add_u32 v6, v116, 4, v6
    s_lshl_b32 s4, s4, 15
    s_lshl_b32 s5, s57, 16
    s_add_u32 s4, s4, s5
    s_lshl_b32 s5, s58, 7
    s_add_u32 s33, s4, s5
    s_lshl_b32 s11, s59, 6
    s_add_u32 s11, s11, s61
    s_lshl_b32 s11, s11, 10
    s_add_u32 s11, s11, 0x800000
    s_lshl_b32 s13, s59, 17
    s_add_u32 s14, s13, 0x400000
    s_mov_b32 s10, 0x1000000
    s_and_b32 s4, s2, 3
    s_add_u32 s5, s4, 3
    s_and_b32 s5, s5, 3
    s_xor_b32 s6, s4, 2
    s_and_b32 s7, s2, 1
    s_mul_i32 s7, s7, 0x1011
    s_lshl_b32 s9, s4, 8
    s_add_u32 s7, s7, s9
    s_add_u32 s7, s7, 0x420
    s_mul_i32 s6, s6, 0x110
    s_add_u32 s5, s5, s6
    s_add_u32 s5, s5, 0x404
    v_bfe_u32 v133, v1, 2, 2
    v_and_b32 v136, 3, v1
    v_lshl_add_u32 v133, v136, 3, v133
    v_lshlrev_b32 v133, 7, v133
    v_lshrrev_b32 v136, 4, v1
    v_lshlrev_b32 v136, 2, v136
    v_bfe_u32 v138, s7, v136, 4
    v_lshl_add_u32 v138, v138, 12, v133
    v_bfe_u32 v140, s5, v136, 4
    v_lshl_add_u32 v140, v140, 12, v133
    s_and_b32 s4, s2, 4
    s_lshl_b32 s4, s4, 7
    v_add_u32 v138, s4, v138
    v_add_u32 v140, s4, v140
    v_and_b32 v133, 0xc80, v133
    s_lshr_b32 s4, s56, 1
    s_lshl_b32 s4, s4, 8
    s_lshr_b32 s5, s57, 2
    s_lshl_b32 s5, s5, 12
    s_add_u32 s4, s4, s5
    v_add_u32 v133, s4, v133
    v_cmp_lt_u32 vcc, 47, v1
    s_bfe_u32 s4, s2, 0x10001
    s_lshl_b32 s4, s4, 15
    v_cndmask_b32 v140, v140, v133, vcc
    s_add_u32 s16, s14, s4
    s_xor_b32 s4, s4, 0x8000
    s_add_u32 s21, s14, s4
    v_lshrrev_b32 v133, 3, v1
    v_bfe_u32 v136, v1, 4, 1
    v_lshlrev_b32 v136, 2, v136
    v_and_b32 v139, 7, v1
    v_xor_b32 v139, v139, v136
    v_lshlrev_b32 v139, 4, v139
    v_lshl_add_u32 v139, v133, 10, v139
    v_mov_b32 v128, 0xdddddddd
    s_mov_b32 s22, 0x0000ffff
    s_mov_b32 s23, 0x0000ffff
    v_lshrrev_b32 v137, 5, v1
    v_and_b32 v132, 15, v1
    s_waitcnt vmcnt(0)
    s_barrier
    v_lshlrev_b32 v132, 4, v132
    v_lshl_add_u32 v132, v137, 8, v132
    v_add_u32 v132, 1024, v132
    s_lshl_b32 s4, s56, 11
    s_add_u32 s4, s4, 131072
    v_add_u32 v129, s4, v14
    v_add_u32 v130, s4, v132
    s_lshl_b32 s4, s56, 10
    s_add_u32 s4, s4, 155648
    v_add_u32 v131, s4, v14
    v_and_b32 v134, 31, v1
    v_lshlrev_b32 v137, 3, v137
    v_sub_u32 v137, v134, v137
    v_and_b32 v133, 0x1b, v134
    v_cmp_eq_u32 vcc, 16, v133
    v_mov_b32 v136, 0x3f803f80
    v_mov_b32 v133, 0
    v_cndmask_b32 v144, v133, v136, vcc
    v_cndmask_b32 v145, v133, v136, vcc
    v_cndmask_b32 v146, v133, v136, vcc
    v_cndmask_b32 v147, v133, v136, vcc
    v_cndmask_b32 v148, v133, v136, vcc
    v_cndmask_b32 v149, v133, v136, vcc
    v_cndmask_b32 v150, v133, v136, vcc
    v_cndmask_b32 v151, v133, v136, vcc
    v_cndmask_b32 v152, v133, v136, vcc
    v_cndmask_b32 v153, v133, v136, vcc
    v_cndmask_b32 v154, v133, v136, vcc
    v_cndmask_b32 v155, v133, v136, vcc
    v_cndmask_b32 v156, v133, v136, vcc
    v_cndmask_b32 v157, v133, v136, vcc
    v_cndmask_b32 v158, v133, v136, vcc
    v_cndmask_b32 v159, v133, v136, vcc
    s_mov_b32 s5, 0xff800000
    s_cmp_eq_u32 s60, 0
    s_cselect_b32 s6, s5, 0
    s_cselect_b32 s7, s56, 64
    v_mov_b32 v135, s5
    s_mov_b32 s8, 0
    s_lshl_b32 s15, s61, 6
    s_add_u32 s15, s15, s59
    s_lshl_b32 s15, s15, 10
    s_add_u32 s15, s15, 0xc00000
    v_mov_b32 v133, s5
    v_mov_b32 v136, s6
    s_cmp_ge_u32 s66, 1
    s_cbranch_scc1 L_nokv
    buffer_load_dword v124, v138, s[36:39], s10 offen sc1
    s_mov_b32 s62, 131072
    s_branch L_chk1
L_spin1:
    buffer_load_dword v124, v138, s[36:39], s10 offen sc1
L_chk1:
    s_waitcnt vmcnt(0)
    v_cmp_le_u32 vcc, 1, v124
    s_sub_u32 s62, s62, 1
    s_cbranch_scc1 L_ok1
    s_cmp_eq_u64 vcc, -1
    s_cbranch_scc0 L_spin1
L_ok1:
    s_mul_i32 s62, s66, 8192
    s_lshl_b32 s63, s56, 10
    s_sub_u32 s63, s11, s63
    s_add_u32 s63, s63, s62
    s_add_u32 s63, s63, 0x200000
    s_add_u32 m0, s62, 155648
    s_add_u32 s64, s63, 0
    buffer_load_dwordx4 v14, s[36:39], s64 offen offset:0 sc1 lds
    buffer_load_dwordx4 v14, s[36:39], s64 offen offset:1024 sc1 lds
    buffer_load_dwordx4 v14, s[36:39], s64 offen offset:2048 sc1 lds
    buffer_load_dwordx4 v14, s[36:39], s64 offen offset:3072 sc1 lds
    s_add_u32 m0, s62, 159744
    s_add_u32 s64, s63, 4096
    buffer_load_dwordx4 v14, s[36:39], s64 offen offset:0 sc1 lds
    buffer_load_dwordx4 v14, s[36:39], s64 offen offset:1024 sc1 lds
    buffer_load_dwordx4 v14, s[36:39], s64 offen offset:2048 sc1 lds
    buffer_load_dwordx4 v14, s[36:39], s64 offen offset:3072 sc1 lds
    s_mul_i32 s62, s66, 32768
    s_add_u32 s63, s62, s16
    s_add_u32 m0, s62, 0
    s_add_u32 s64, s63, 0
    buffer_load_dwordx4 v14, s[36:39], s64 offen offset:0 sc1 lds
    buffer_load_dwordx4 v14, s[36:39], s64 offen offset:1024 sc1 lds
    buffer_load_dwordx4 v14, s[36:39], s64 offen offset:2048 sc1 lds
    buffer_load_dwordx4 v14, s[36:39], s64 offen offset:3072 sc1 lds
    s_add_u32 m0, s62, 4096
    s_add_u32 s64, s63, 4096
    buffer_load_dwordx4 v14, s[36:39], s64 offen offset:0 sc1 lds
    buffer_load_dwordx4 v14, s[36:39], s64 offen offset:1024 sc1 lds
    buffer_load_dwordx4 v14, s[36:39], s64 offen offset:2048 sc1 lds
    buffer_load_dwordx4 v14, s[36:39], s64 offen offset:3072 sc1 lds
    s_add_u32 m0, s62, 8192
    s_add_u32 s64, s63, 8192
    buffer_load_dwordx4 v14, s[36:39], s64 offen offset:0 sc1 lds
    buffer_load_dwordx4 v14, s[36:39], s64 offen offset:1024 sc1 lds
    buffer_load_dwordx4 v14, s[36:39], s64 offen offset:2048 sc1 lds
    buffer_load_dwordx4 v14, s[36:39], s64 offen offset:3072 sc1 lds
    s_add_u32 m0, s62, 12288
    s_add_u32 s64, s63, 12288
    buffer_load_dwordx4 v14, s[36:39], s64 offen offset:0 sc1 lds
    buffer_load_dwordx4 v14, s[36:39], s64 offen offset:1024 sc1 lds
    buffer_load_dwordx4 v14, s[36:39], s64 offen offset:2048 sc1 lds
    buffer_load_dwordx4 v14, s[36:39], s64 offen offset:3072 sc1 lds
    s_add_u32 m0, s62, 16384
    s_add_u32 s64, s63, 16384
    buffer_load_dwordx4 v14, s[36:39], s64 offen offset:0 sc1 lds
    buffer_load_dwordx4 v14, s[36:39], s64 offen offset:1024 sc1 lds
    buffer_load_dwordx4 v14, s[36:39], s64 offen offset:2048 sc1 lds
    buffer_load_dwordx4 v14, s[36:39], s64 offen offset:3072 sc1 lds
    s_add_u32 m0, s62, 20480
    s_add_u32 s64, s63, 20480
    buffer_load_dwordx4 v14, s[36:39], s64 offen offset:0 sc1 lds
    buffer_load_dwordx4 v14, s[36:39], s64 offen offset:1024 sc1 lds
    buffer_load_dwordx4 v14, s[36:39], s64 offen offset:2048 sc1 lds
    buffer_load_dwordx4 v14, s[36:39], s64 offen offset:3072 sc1 lds
    s_add_u32 m0, s62, 24576
    s_add_u32 s64, s63, 24576
    buffer_load_dwordx4 v14, s[36:39], s64 offen offset:0 sc1 lds
    buffer_load_dwordx4 v14, s[36:39], s64 offen offset:1024 sc1 lds
    buffer_load_dwordx4 v14, s[36:39], s64 offen offset:2048 sc1 lds
    buffer_load_dwordx4 v14, s[36:39], s64 offen offset:3072 sc1 lds
    s_add_u32 m0, s62, 28672
    s_add_u32 s64, s63, 28672
    buffer_load_dwordx4 v14, s[36:39], s64 offen offset:0 sc1 lds
    buffer_load_dwordx4 v14, s[36:39], s64 offen offset:1024 sc1 lds
    buffer_load_dwordx4 v14, s[36:39], s64 offen offset:2048 sc1 lds
    buffer_load_dwordx4 v14, s[36:39], s64 offen offset:3072 sc1 lds
    s_waitcnt vmcnt(24)
    s_add_u32 m0, s62, 32768
    s_add_u32 s64, s63, 65536
    buffer_load_dwordx4 v14, s[36:39], s64 offen offset:0 sc1 lds
    buffer_load_dwordx4 v14, s[36:39], s64 offen offset:1024 sc1 lds
    buffer_load_dwordx4 v14, s[36:39], s64 offen offset:2048 sc1 lds
    buffer_load_dwordx4 v14, s[36:39], s64 offen offset:3072 sc1 lds
    s_add_u32 m0, s62, 36864
    s_add_u32 s64, s63, 69632
    buffer_load_dwordx4 v14, s[36:39], s64 offen offset:0 sc1 lds
    buffer_load_dwordx4 v14, s[36:39], s64 offen offset:1024 sc1 lds
    buffer_load_dwordx4 v14, s[36:39], s64 offen offset:2048 sc1 lds
    buffer_load_dwordx4 v14, s[36:39], s64 offen offset:3072 sc1 lds
    s_add_u32 m0, s62, 40960
    s_add_u32 s64, s63, 73728
    buffer_load_dwordx4 v14, s[36:39], s64 offen offset:0 sc1 lds
    buffer_load_dwordx4 v14, s[36:39], s64 offen offset:1024 sc1 lds
    buffer_load_dwordx4 v14, s[36:39], s64 offen offset:2048 sc1 lds
    buffer_load_dwordx4 v14, s[36:39], s64 offen offset:3072 sc1 lds
    s_add_u32 m0, s62, 45056
    s_add_u32 s64, s63, 77824
    buffer_load_dwordx4 v14, s[36:39], s64 offen offset:0 sc1 lds
    buffer_load_dwordx4 v14, s[36:39], s64 offen offset:1024 sc1 lds
    buffer_load_dwordx4 v14, s[36:39], s64 offen offset:2048 sc1 lds
    buffer_load_dwordx4 v14, s[36:39], s64 offen offset:3072 sc1 lds
    s_add_u32 m0, s62, 49152
    s_add_u32 s64, s63, 81920
    buffer_load_dwordx4 v14, s[36:39], s64 offen offset:0 sc1 lds
    buffer_load_dwordx4 v14, s[36:39], s64 offen offset:1024 sc1 lds
    buffer_load_dwordx4 v14, s[36:39], s64 offen offset:2048 sc1 lds
    buffer_load_dwordx4 v14, s[36:39], s64 offen offset:3072 sc1 lds
    s_add_u32 m0, s62, 53248
    s_add_u32 s64, s63, 86016
    buffer_load_dwordx4 v14, s[36:39], s64 offen offset:0 sc1 lds
    buffer_load_dwordx4 v14, s[36:39], s64 offen offset:1024 sc1 lds
    buffer_load_dwordx4 v14, s[36:39], s64 offen offset:2048 sc1 lds
    buffer_load_dwordx4 v14, s[36:39], s64 offen offset:3072 sc1 lds
    s_add_u32 m0, s62, 57344
    s_add_u32 s64, s63, 90112
    buffer_load_dwordx4 v14, s[36:39], s64 offen offset:0 sc1 lds
    buffer_load_dwordx4 v14, s[36:39], s64 offen offset:1024 sc1 lds
    buffer_load_dwordx4 v14, s[36:39], s64 offen offset:2048 sc1 lds
    buffer_load_dwordx4 v14, s[36:39], s64 offen offset:3072 sc1 lds
    s_add_u32 m0, s62, 61440
    s_add_u32 s64, s63, 94208
    buffer_load_dwordx4 v14, s[36:39], s64 offen offset:0 sc1 lds
    buffer_load_dwordx4 v14, s[36:39], s64 offen offset:1024 sc1 lds
    buffer_load_dwordx4 v14, s[36:39], s64 offen offset:2048 sc1 lds
    buffer_load_dwordx4 v14, s[36:39], s64 offen offset:3072 sc1 lds
L_nokv:
    v_cmp_le_i32 vcc, 0, v137
    v_mov_b32 v160, 0
    s_nop 0
    v_cndmask_b32 v176, v133, v160, vcc
    v_cndmask_b32 v192, v136, v133, vcc
    v_cmp_le_i32 vcc, 1, v137
    v_mov_b32 v161, 0
    s_nop 0
    v_cndmask_b32 v177, v133, v161, vcc
    v_cndmask_b32 v193, v136, v133, vcc
    v_cmp_le_i32 vcc, 2, v137
    v_mov_b32 v162, 0
    s_nop 0
    v_cndmask_b32 v178, v133, v162, vcc
    v_cndmask_b32 v194, v136, v133, vcc
    v_cmp_le_i32 vcc, 3, v137
    v_mov_b32 v163, 0
    s_nop 0
    v_cndmask_b32 v179, v133, v163, vcc
    v_cndmask_b32 v195, v136, v133, vcc
    v_cmp_le_i32 vcc, 4, v137
    v_mov_b32 v164, 0
    s_nop 0
    v_cndmask_b32 v180, v133, v164, vcc
    v_cndmask_b32 v196, v136, v133, vcc
    v_cmp_le_i32 vcc, 5, v137
    v_mov_b32 v165, 0
    s_nop 0
    v_cndmask_b32 v181, v133, v165, vcc
    v_cndmask_b32 v197, v136, v133, vcc
    v_cmp_le_i32 vcc, 6, v137
    v_mov_b32 v166, 0
    s_nop 0
    v_cndmask_b32 v182, v133, v166, vcc
    v_cndmask_b32 v198, v136, v133, vcc
    v_cmp_le_i32 vcc, 7, v137
    v_mov_b32 v167, 0
    s_nop 0
    v_cndmask_b32 v183, v133, v167, vcc
    v_cndmask_b32 v199, v136, v133, vcc
    v_cmp_le_i32 vcc, 16, v137
    v_mov_b32 v168, 0
    s_nop 0
    v_cndmask_b32 v184, v133, v168, vcc
    v_cndmask_b32 v200, v136, v133, vcc
    v_cmp_le_i32 vcc, 17, v137
    v_mov_b32 v169, 0
    s_nop 0
    v_cndmask_b32 v185, v133, v169, vcc
    v_cndmask_b32 v201, v136, v133, vcc
    v_cmp_le_i32 vcc, 18, v137
    v_mov_b32 v170, 0
    s_nop 0
    v_cndmask_b32 v186, v133, v170, vcc
    v_cndmask_b32 v202, v136, v133, vcc
    v_cmp_le_i32 vcc, 19, v137
    v_mov_b32 v171, 0
    s_nop 0
    v_cndmask_b32 v187, v133, v171, vcc
    v_cndmask_b32 v203, v136, v133, vcc
    v_cmp_le_i32 vcc, 20, v137
    v_mov_b32 v172, 0
    s_nop 0
    v_cndmask_b32 v188, v133, v172, vcc
    v_cndmask_b32 v204, v136, v133, vcc
    v_cmp_le_i32 vcc, 21, v137
    v_mov_b32 v173, 0
    s_nop 0
    v_cndmask_b32 v189, v133, v173, vcc
    v_cndmask_b32 v205, v136, v133, vcc
    v_cmp_le_i32 vcc, 22, v137
    v_mov_b32 v174, 0
    s_nop 0
    v_cndmask_b32 v190, v133, v174, vcc
    v_cndmask_b32 v206, v136, v133, vcc
    v_cmp_le_i32 vcc, 23, v137
    v_mov_b32 v175, 0
    s_nop 0
    v_cndmask_b32 v191, v133, v175, vcc
    v_cndmask_b32 v207, v136, v133, vcc
    s_waitcnt vmcnt(32)
    s_barrier
    s_branch L_attn
L_compute:
    s_getpc_b64 s[62:63]
L_pc:
    s_cmp_eq_u32 s56, 2
    s_cbranch_scc0 L_nocpf
    s_lshr_b32 s64, s2, 3
    s_lshl_b32 s64, s64, 7
    v_and_b32 v20, 15, v1
    v_lshlrev_b32 v20, 12, v20
    v_add_u32 v20, s64, v20
    s_sub_u32 s62, s62, L_pc-gated_mix__sliding_block__softmax_full_mha__prompt_kernel
    s_subb_u32 s63, s63, 0
    v_min_u32 v20, L_code_end-gated_mix__sliding_block__softmax_full_mha__prompt_kernel-4, v20
    v_mov_b32 v21, s63
    v_add_co_u32 v20, vcc, s62, v20
    s_nop 1
    v_addc_co_u32 v21, vcc, 0, v21, vcc
    global_load_dword v255, v[20:21], off
L_nocpf:
    v_lshrrev_b32 v16, 5, v1
    v_and_b32 v17, 31, v1
    v_lshrrev_b32 v18, 1, v17
    v_and_b32 v18, 7, v18
    s_lshl_b32 s62, s56, 12
    s_add_u32 s62, s62, 32768
    v_lshlrev_b32 v19, 7, v17
    v_add_u32 v19, s62, v19
    v_add_u32 v20, 0, v16
    v_xor_b32 v20, v20, v18
    v_lshl_add_u32 v2, v20, 4, v19
    v_add_u32 v6, 0x10000, v2
    v_add_u32 v20, 2, v16
    v_xor_b32 v20, v20, v18
    v_lshl_add_u32 v3, v20, 4, v19
    v_add_u32 v7, 0x10000, v3
    v_add_u32 v20, 4, v16
    v_xor_b32 v20, v20, v18
    v_lshl_add_u32 v4, v20, 4, v19
    v_add_u32 v8, 0x10000, v4
    v_add_u32 v20, 6, v16
    v_xor_b32 v20, v20, v18
    v_lshl_add_u32 v5, v20, 4, v19
    v_add_u32 v9, 0x10000, v5
    v_bfe_u32 v18, v1, 2, 2
    v_lshl_add_u32 v19, v16, 3, v18
    v_lshlrev_b32 v19, 7, v19
    v_bfe_u32 v20, v1, 4, 1
    v_lshlrev_b32 v20, 1, v20
    v_bfe_u32 v21, v1, 1, 1
    v_add_u32 v20, v20, v21
    v_bfe_u32 v21, v1, 3, 1
    v_lshl_or_b32 v20, v21, 2, v20
    v_lshl_add_u32 v19, v20, 4, v19
    v_and_b32 v20, 1, v1
    v_lshl_add_u32 v19, v20, 3, v19
    v_add_u32 v10, 32768, v19
    v_xor_b32 v11, 64, v10
    v_add_u32 v12, 0x10000, v10
    v_add_u32 v13, 0x10000, v11
    v_lshlrev_b32 v15, 4, v16
    v_add_u32 v15, 28672, v15
    s_lshl_b32 s57, s68, 1
    s_and_b32 s62, s69, 1
    s_add_u32 s57, s57, s62
    s_and_b32 s58, s2, 4
    s_lshr_b32 s62, s69, 1
    s_add_u32 s58, s58, s62
    s_and_b32 s59, s2, 7
    s_lshl_b32 s59, s59, 2
    s_bfe_u32 s62, s2, 0x20003
    s_add_u32 s59, s59, s62
    s_mov_b32 s60, s69
    s_lshl_b32 s61, s60, 3
    s_add_u32 s61, s61, s56
    s_lshr_b32 s64, s69, 1
    s_xor_b32 s64, s64, s2
    s_and_b32 s64, s64, 1
    s_lshl_b32 s64, s64, 1
    s_and_b32 s65, s69, 1
    s_add_u32 s65, s65, s64
    s_xor_b32 s64, s65, 2
    s_and_b32 s22, s69, 3
    s_add_u32 s23, s69, 1
    s_and_b32 s23, s23, 3
    s_cmp_lt_u32 s69, 4
    s_cselect_b32 s64, s64, s22
    s_cselect_b32 s65, s65, s23
    s_and_b32 s22, s2, 4
    s_add_u32 s64, s64, s22
    s_add_u32 s65, s65, s22
    s_lshl_b32 s66, s68, 2
    s_add_u32 s66, s66, s56
    s_lshl_b32 s62, s64, 8
    s_add_u32 s62, s62, s66
    s_add_u32 s62, s62, 2048
    s_xor_b32 s64, s69, 2
    s_and_b32 s64, s64, 3
    s_add_u32 s64, s64, s22
    s_lshl_b32 s64, s64, 8
    s_add_u32 s64, s64, s66
    s_lshl_b32 s24, s62, 11
    s_lshl_b32 s25, s62, 10
    s_add_u32 s25, s25, 0x800000
    s_lshl_b32 s26, s64, 11
    s_lshl_b32 s27, s64, 10
    s_add_u32 s27, s27, 0x800000
    s_mov_b32 s28, 0x10000
    s_mov_b32 s29, 0x20000
    s_cmp_lt_u32 s69, 4
    s_cselect_b32 s24, s24, s25
    s_cselect_b32 s25, s29, s28
    s_cselect_b32 s26, s27, s26
    s_cselect_b32 s27, s28, s29
    s_cselect_b32 s64, 2048, 0
    s_lshl_b32 s62, s65, 8
    s_add_u32 s62, s62, s66
    s_add_u32 s62, s62, s64
    s_lshl_b32 s28, s62, 11
    s_add_u32 s29, s28, 0x40000
    s_mov_b32 s32, 0x3eb8aa3b
    v_mov_b32 v0, 0
    s_waitcnt lgkmcnt(0)
    s_mov_b32 s36, s20
    s_and_b32 s37, s21, 0xffff
    s_mov_b32 s38, 0x1200000
    s_mov_b32 s39, 0x20000
    s_mov_b32 s44, s16
    s_and_b32 s45, s17, 0xffff
    s_mov_b32 s46, 0x200000
    s_mov_b32 s47, 0x20000
    s_mov_b32 s48, s18
    s_and_b32 s49, s19, 0xffff
    s_mov_b32 s50, 0x100
    s_mov_b32 s51, 0x20000
    s_mov_b32 s40, s10
    s_and_b32 s41, s11, 0xffff
    s_mov_b32 s42, 0x80000
    s_mov_b32 s43, 0x20000
    s_mov_b32 s52, s14
    s_and_b32 s53, s15, 0xffff
    s_mov_b32 s54, 0x80000
    s_mov_b32 s55, 0x20000
    v_mov_b32 v20, 0
    v_mov_b32 v21, 0
    v_mov_b32 v22, 0
    v_mov_b32 v23, 0
    v_mov_b32 v254, 1
    s_lshl_b32 s35, s56, 8
    s_add_u32 s35, s35, s2
    s_sub_u32 s35, s35, 768
    s_cmp_lt_u32 s35, 16
    s_cbranch_scc0 L_noinit
    s_mul_i32 s62, s2, 4096
    s_add_u32 s62, s62, 0x1000000
    s_add_u32 s63, s62, 4096
    buffer_store_dwordx4 v[20:23], v14, s[36:39], s62 offen offset:0 sc1
    buffer_store_dwordx4 v[20:23], v14, s[36:39], s62 offen offset:1024 sc1
    buffer_store_dwordx4 v[20:23], v14, s[36:39], s62 offen offset:2048 sc1
    buffer_store_dwordx4 v[20:23], v14, s[36:39], s62 offen offset:3072 sc1
L_noinit:
    s_cmp_lt_u32 s69, 2
    s_cbranch_scc0 L_p12q
    s_barrier
    ds_read_b128 v[128:131], v2 offset:0
    ds_read_b64_tr_b16 v[16:17], v10 offset:16384
    ds_read_b64_tr_b16 v[18:19], v10 offset:16896
    ds_read_b64_tr_b16 v[20:21], v11 offset:16384
    ds_read_b64_tr_b16 v[22:23], v11 offset:16896
    ds_read_b128 v[132:135], v3 offset:0
    ds_read_b64_tr_b16 v[24:25], v10 offset:18432
    ds_read_b64_tr_b16 v[26:27], v10 offset:18944
    ds_read_b64_tr_b16 v[28:29], v11 offset:18432
    ds_read_b64_tr_b16 v[30:31], v11 offset:18944
    ds_read_b128 v[136:139], v4 offset:0
    ds_read_b64_tr_b16 v[32:33], v10 offset:20480
    ds_read_b64_tr_b16 v[34:35], v10 offset:20992
    ds_read_b64_tr_b16 v[36:37], v11 offset:20480
    ds_read_b64_tr_b16 v[38:39], v11 offset:20992
    ds_read_b128 v[140:143], v5 offset:0
    ds_read_b64_tr_b16 v[40:41], v10 offset:22528
    ds_read_b64_tr_b16 v[42:43], v10 offset:23040
    ds_read_b64_tr_b16 v[44:45], v11 offset:22528
    ds_read_b64_tr_b16 v[46:47], v11 offset:23040
    ds_read_b128 v[112:115], v15 offset:0
    ds_read_b128 v[116:119], v15 offset:32
    ds_read_b128 v[120:123], v15 offset:64
    ds_read_b128 v[124:127], v15 offset:96
    s_waitcnt lgkmcnt(0)
    v_mfma_f32_32x32x16_bf16 v[80:95], v[128:131], v[16:19], 0
    s_barrier
    ds_read_b128 v[144:147], v2 offset:32768
    ds_read_b64_tr_b16 v[48:49], v10 offset:49152
    ds_read_b64_tr_b16 v[50:51], v10 offset:49664
    ds_read_b64_tr_b16 v[52:53], v11 offset:49152
    v_dot2_f32_bf16 v0, v128, v112, v0
    v_dot2_f32_bf16 v0, v129, v113, v0
    v_dot2_f32_bf16 v0, v130, v114, v0
    v_dot2_f32_bf16 v0, v131, v115, v0
    v_mfma_f32_32x32x16_bf16 v[96:111], v[128:131], v[20:23], 0
    ds_read_b64_tr_b16 v[54:55], v11 offset:49664
    ds_read_b128 v[148:151], v3 offset:32768
    ds_read_b64_tr_b16 v[56:57], v10 offset:51200
    ds_read_b64_tr_b16 v[58:59], v10 offset:51712
    v_dot2_f32_bf16 v0, v132, v116, v0
    v_dot2_f32_bf16 v0, v133, v117, v0
    v_dot2_f32_bf16 v0, v134, v118, v0
    v_dot2_f32_bf16 v0, v135, v119, v0
    v_mfma_f32_32x32x16_bf16 v[80:95], v[132:135], v[24:27], v[80:95]
    ds_read_b64_tr_b16 v[60:61], v11 offset:51200
    ds_read_b64_tr_b16 v[62:63], v11 offset:51712
    ds_read_b128 v[152:155], v4 offset:32768
    ds_read_b64_tr_b16 v[64:65], v10 offset:53248
    v_dot2_f32_bf16 v0, v136, v120, v0
    v_dot2_f32_bf16 v0, v137, v121, v0
    v_dot2_f32_bf16 v0, v138, v122, v0
    v_dot2_f32_bf16 v0, v139, v123, v0
    v_mfma_f32_32x32x16_bf16 v[96:111], v[132:135], v[28:31], v[96:111]
    ds_read_b64_tr_b16 v[66:67], v10 offset:53760
    ds_read_b64_tr_b16 v[68:69], v11 offset:53248
    ds_read_b64_tr_b16 v[70:71], v11 offset:53760
    ds_read_b128 v[156:159], v5 offset:32768
    v_dot2_f32_bf16 v0, v140, v124, v0
    v_dot2_f32_bf16 v0, v141, v125, v0
    v_dot2_f32_bf16 v0, v142, v126, v0
    v_dot2_f32_bf16 v0, v143, v127, v0
    v_mfma_f32_32x32x16_bf16 v[80:95], v[136:139], v[32:35], v[80:95]
    ds_read_b64_tr_b16 v[72:73], v10 offset:55296
    ds_read_b64_tr_b16 v[74:75], v10 offset:55808
    ds_read_b64_tr_b16 v[76:77], v11 offset:55296
    ds_read_b64_tr_b16 v[78:79], v11 offset:55808
    ds_read_b128 v[112:115], v15 offset:128
    ds_read_b128 v[116:119], v15 offset:160
    ds_read_b128 v[120:123], v15 offset:192
    ds_read_b128 v[124:127], v15 offset:224
    v_mfma_f32_32x32x16_bf16 v[96:111], v[136:139], v[36:39], v[96:111]
    v_mfma_f32_32x32x16_bf16 v[80:95], v[140:143], v[40:43], v[80:95]
    v_mfma_f32_32x32x16_bf16 v[96:111], v[140:143], v[44:47], v[96:111]
    s_waitcnt lgkmcnt(0)
    v_mfma_f32_32x32x16_bf16 v[80:95], v[144:147], v[48:51], v[80:95]
    s_barrier
    s_cmp_lt_u32 s35, 16
    s_cbranch_scc0 L_noinit2v
    s_mul_i32 s62, s2, 16
    s_waitcnt vmcnt(0)
    s_mov_b64 exec, 1
    buffer_store_dword v254, v14, s[48:51], s62 offen sc1
    s_mov_b64 exec, -1
L_noinit2v:
    ds_read_b128 v[160:163], v6 offset:0
    ds_read_b64_tr_b16 v[16:17], v12 offset:16384
    ds_read_b64_tr_b16 v[18:19], v12 offset:16896
    ds_read_b64_tr_b16 v[20:21], v13 offset:16384
    v_dot2_f32_bf16 v0, v144, v112, v0
    v_dot2_f32_bf16 v0, v145, v113, v0
    v_dot2_f32_bf16 v0, v146, v114, v0
    v_dot2_f32_bf16 v0, v147, v115, v0
    v_mfma_f32_32x32x16_bf16 v[96:111], v[144:147], v[52:55], v[96:111]
    ds_read_b64_tr_b16 v[22:23], v13 offset:16896
    ds_read_b128 v[164:167], v7 offset:0
    ds_read_b64_tr_b16 v[24:25], v12 offset:18432
    ds_read_b64_tr_b16 v[26:27], v12 offset:18944
    v_dot2_f32_bf16 v0, v148, v116, v0
    v_dot2_f32_bf16 v0, v149, v117, v0
    v_dot2_f32_bf16 v0, v150, v118, v0
    v_dot2_f32_bf16 v0, v151, v119, v0
    v_mfma_f32_32x32x16_bf16 v[80:95], v[148:151], v[56:59], v[80:95]
    ds_read_b64_tr_b16 v[28:29], v13 offset:18432
    ds_read_b64_tr_b16 v[30:31], v13 offset:18944
    ds_read_b128 v[168:171], v8 offset:0
    ds_read_b64_tr_b16 v[32:33], v12 offset:20480
    v_dot2_f32_bf16 v0, v152, v120, v0
    v_dot2_f32_bf16 v0, v153, v121, v0
    v_dot2_f32_bf16 v0, v154, v122, v0
    v_dot2_f32_bf16 v0, v155, v123, v0
    v_mfma_f32_32x32x16_bf16 v[96:111], v[148:151], v[60:63], v[96:111]
    ds_read_b64_tr_b16 v[34:35], v12 offset:20992
    ds_read_b64_tr_b16 v[36:37], v13 offset:20480
    ds_read_b64_tr_b16 v[38:39], v13 offset:20992
    ds_read_b128 v[172:175], v9 offset:0
    v_dot2_f32_bf16 v0, v156, v124, v0
    v_dot2_f32_bf16 v0, v157, v125, v0
    v_dot2_f32_bf16 v0, v158, v126, v0
    v_dot2_f32_bf16 v0, v159, v127, v0
    v_mfma_f32_32x32x16_bf16 v[80:95], v[152:155], v[64:67], v[80:95]
    ds_read_b64_tr_b16 v[40:41], v12 offset:22528
    ds_read_b64_tr_b16 v[42:43], v12 offset:23040
    ds_read_b64_tr_b16 v[44:45], v13 offset:22528
    ds_read_b64_tr_b16 v[46:47], v13 offset:23040
    ds_read_b128 v[112:115], v15 offset:256
    ds_read_b128 v[116:119], v15 offset:288
    ds_read_b128 v[120:123], v15 offset:320
    ds_read_b128 v[124:127], v15 offset:352
    v_mfma_f32_32x32x16_bf16 v[96:111], v[152:155], v[68:71], v[96:111]
    v_mfma_f32_32x32x16_bf16 v[80:95], v[156:159], v[72:75], v[80:95]
    v_mfma_f32_32x32x16_bf16 v[96:111], v[156:159], v[76:79], v[96:111]
    s_waitcnt lgkmcnt(0)
    v_mfma_f32_32x32x16_bf16 v[80:95], v[160:163], v[16:19], v[80:95]
    s_barrier
    ds_read_b128 v[176:179], v6 offset:32768
    ds_read_b64_tr_b16 v[48:49], v12 offset:49152
    ds_read_b64_tr_b16 v[50:51], v12 offset:49664
    ds_read_b64_tr_b16 v[52:53], v13 offset:49152
    v_dot2_f32_bf16 v0, v160, v112, v0
    v_dot2_f32_bf16 v0, v161, v113, v0
    v_dot2_f32_bf16 v0, v162, v114, v0
    v_dot2_f32_bf16 v0, v163, v115, v0
    v_mfma_f32_32x32x16_bf16 v[96:111], v[160:163], v[20:23], v[96:111]
    ds_read_b64_tr_b16 v[54:55], v13 offset:49664
    ds_read_b128 v[180:183], v7 offset:32768
    ds_read_b64_tr_b16 v[56:57], v12 offset:51200
    ds_read_b64_tr_b16 v[58:59], v12 offset:51712
    v_dot2_f32_bf16 v0, v164, v116, v0
    v_dot2_f32_bf16 v0, v165, v117, v0
    v_dot2_f32_bf16 v0, v166, v118, v0
    v_dot2_f32_bf16 v0, v167, v119, v0
    v_mfma_f32_32x32x16_bf16 v[80:95], v[164:167], v[24:27], v[80:95]
    ds_read_b64_tr_b16 v[60:61], v13 offset:51200
    ds_read_b64_tr_b16 v[62:63], v13 offset:51712
    ds_read_b128 v[184:187], v8 offset:32768
    ds_read_b64_tr_b16 v[64:65], v12 offset:53248
    v_dot2_f32_bf16 v0, v168, v120, v0
    v_dot2_f32_bf16 v0, v169, v121, v0
    v_dot2_f32_bf16 v0, v170, v122, v0
    v_dot2_f32_bf16 v0, v171, v123, v0
    v_mfma_f32_32x32x16_bf16 v[96:111], v[164:167], v[28:31], v[96:111]
    ds_read_b64_tr_b16 v[66:67], v12 offset:53760
    ds_read_b64_tr_b16 v[68:69], v13 offset:53248
    ds_read_b64_tr_b16 v[70:71], v13 offset:53760
    ds_read_b128 v[188:191], v9 offset:32768
    v_dot2_f32_bf16 v0, v172, v124, v0
    v_dot2_f32_bf16 v0, v173, v125, v0
    v_dot2_f32_bf16 v0, v174, v126, v0
    v_dot2_f32_bf16 v0, v175, v127, v0
    v_mfma_f32_32x32x16_bf16 v[80:95], v[168:171], v[32:35], v[80:95]
    ds_read_b64_tr_b16 v[72:73], v12 offset:55296
    ds_read_b64_tr_b16 v[74:75], v12 offset:55808
    ds_read_b64_tr_b16 v[76:77], v13 offset:55296
    ds_read_b64_tr_b16 v[78:79], v13 offset:55808
    ds_read_b128 v[112:115], v15 offset:384
    ds_read_b128 v[116:119], v15 offset:416
    ds_read_b128 v[120:123], v15 offset:448
    ds_read_b128 v[124:127], v15 offset:480
    v_mfma_f32_32x32x16_bf16 v[96:111], v[168:171], v[36:39], v[96:111]
    v_mfma_f32_32x32x16_bf16 v[80:95], v[172:175], v[40:43], v[80:95]
    v_mfma_f32_32x32x16_bf16 v[96:111], v[172:175], v[44:47], v[96:111]
    s_waitcnt lgkmcnt(0)
    v_mfma_f32_32x32x16_bf16 v[80:95], v[176:179], v[48:51], v[80:95]
    s_barrier
    ds_read_b128 v[192:195], v2 offset:0
    ds_read_b64_tr_b16 v[16:17], v10 offset:16384
    ds_read_b64_tr_b16 v[18:19], v10 offset:16896
    ds_read_b64_tr_b16 v[20:21], v11 offset:16384
    v_dot2_f32_bf16 v0, v176, v112, v0
    v_dot2_f32_bf16 v0, v177, v113, v0
    v_dot2_f32_bf16 v0, v178, v114, v0
    v_dot2_f32_bf16 v0, v179, v115, v0
    v_mfma_f32_32x32x16_bf16 v[96:111], v[176:179], v[52:55], v[96:111]
    ds_read_b64_tr_b16 v[22:23], v11 offset:16896
    ds_read_b128 v[196:199], v3 offset:0
    ds_read_b64_tr_b16 v[24:25], v10 offset:18432
    ds_read_b64_tr_b16 v[26:27], v10 offset:18944
    v_dot2_f32_bf16 v0, v180, v116, v0
    v_dot2_f32_bf16 v0, v181, v117, v0
    v_dot2_f32_bf16 v0, v182, v118, v0
    v_dot2_f32_bf16 v0, v183, v119, v0
    v_mfma_f32_32x32x16_bf16 v[80:95], v[180:183], v[56:59], v[80:95]
    ds_read_b64_tr_b16 v[28:29], v11 offset:18432
    ds_read_b64_tr_b16 v[30:31], v11 offset:18944
    ds_read_b128 v[200:203], v4 offset:0
    ds_read_b64_tr_b16 v[32:33], v10 offset:20480
    v_dot2_f32_bf16 v0, v184, v120, v0
    v_dot2_f32_bf16 v0, v185, v121, v0
    v_dot2_f32_bf16 v0, v186, v122, v0
    v_dot2_f32_bf16 v0, v187, v123, v0
    v_mfma_f32_32x32x16_bf16 v[96:111], v[180:183], v[60:63], v[96:111]
    ds_read_b64_tr_b16 v[34:35], v10 offset:20992
    ds_read_b64_tr_b16 v[36:37], v11 offset:20480
    ds_read_b64_tr_b16 v[38:39], v11 offset:20992
    ds_read_b128 v[204:207], v5 offset:0
    v_dot2_f32_bf16 v0, v188, v124, v0
    v_dot2_f32_bf16 v0, v189, v125, v0
    v_dot2_f32_bf16 v0, v190, v126, v0
    v_dot2_f32_bf16 v0, v191, v127, v0
    v_mfma_f32_32x32x16_bf16 v[80:95], v[184:187], v[64:67], v[80:95]
    ds_read_b64_tr_b16 v[40:41], v10 offset:22528
    ds_read_b64_tr_b16 v[42:43], v10 offset:23040
    ds_read_b64_tr_b16 v[44:45], v11 offset:22528
    ds_read_b64_tr_b16 v[46:47], v11 offset:23040
    ds_read_b128 v[112:115], v15 offset:512
    ds_read_b128 v[116:119], v15 offset:544
    ds_read_b128 v[120:123], v15 offset:576
    ds_read_b128 v[124:127], v15 offset:608
    v_mfma_f32_32x32x16_bf16 v[96:111], v[184:187], v[68:71], v[96:111]
    v_mfma_f32_32x32x16_bf16 v[80:95], v[188:191], v[72:75], v[80:95]
    v_mfma_f32_32x32x16_bf16 v[96:111], v[188:191], v[76:79], v[96:111]
    s_waitcnt lgkmcnt(0)
    v_mfma_f32_32x32x16_bf16 v[80:95], v[192:195], v[16:19], v[80:95]
    s_barrier
    ds_read_b128 v[208:211], v2 offset:32768
    ds_read_b64_tr_b16 v[48:49], v10 offset:49152
    ds_read_b64_tr_b16 v[50:51], v10 offset:49664
    ds_read_b64_tr_b16 v[52:53], v11 offset:49152
    v_dot2_f32_bf16 v0, v192, v112, v0
    v_dot2_f32_bf16 v0, v193, v113, v0
    v_dot2_f32_bf16 v0, v194, v114, v0
    v_dot2_f32_bf16 v0, v195, v115, v0
    v_mfma_f32_32x32x16_bf16 v[96:111], v[192:195], v[20:23], v[96:111]
    ds_read_b64_tr_b16 v[54:55], v11 offset:49664
    ds_read_b128 v[212:215], v3 offset:32768
    ds_read_b64_tr_b16 v[56:57], v10 offset:51200
    ds_read_b64_tr_b16 v[58:59], v10 offset:51712
    v_dot2_f32_bf16 v0, v196, v116, v0
    v_dot2_f32_bf16 v0, v197, v117, v0
    v_dot2_f32_bf16 v0, v198, v118, v0
    v_dot2_f32_bf16 v0, v199, v119, v0
    v_mfma_f32_32x32x16_bf16 v[80:95], v[196:199], v[24:27], v[80:95]
    ds_read_b64_tr_b16 v[60:61], v11 offset:51200
    ds_read_b64_tr_b16 v[62:63], v11 offset:51712
    ds_read_b128 v[216:219], v4 offset:32768
    ds_read_b64_tr_b16 v[64:65], v10 offset:53248
    v_dot2_f32_bf16 v0, v200, v120, v0
    v_dot2_f32_bf16 v0, v201, v121, v0
    v_dot2_f32_bf16 v0, v202, v122, v0
    v_dot2_f32_bf16 v0, v203, v123, v0
    v_mfma_f32_32x32x16_bf16 v[96:111], v[196:199], v[28:31], v[96:111]
    ds_read_b64_tr_b16 v[66:67], v10 offset:53760
    ds_read_b64_tr_b16 v[68:69], v11 offset:53248
    ds_read_b64_tr_b16 v[70:71], v11 offset:53760
    ds_read_b128 v[220:223], v5 offset:32768
    v_dot2_f32_bf16 v0, v204, v124, v0
    v_dot2_f32_bf16 v0, v205, v125, v0
    v_dot2_f32_bf16 v0, v206, v126, v0
    v_dot2_f32_bf16 v0, v207, v127, v0
    v_mfma_f32_32x32x16_bf16 v[80:95], v[200:203], v[32:35], v[80:95]
    ds_read_b64_tr_b16 v[72:73], v10 offset:55296
    ds_read_b64_tr_b16 v[74:75], v10 offset:55808
    ds_read_b64_tr_b16 v[76:77], v11 offset:55296
    ds_read_b64_tr_b16 v[78:79], v11 offset:55808
    ds_read_b128 v[112:115], v15 offset:640
    ds_read_b128 v[116:119], v15 offset:672
    ds_read_b128 v[120:123], v15 offset:704
    ds_read_b128 v[124:127], v15 offset:736
    v_mfma_f32_32x32x16_bf16 v[96:111], v[200:203], v[36:39], v[96:111]
    v_mfma_f32_32x32x16_bf16 v[80:95], v[204:207], v[40:43], v[80:95]
    v_mfma_f32_32x32x16_bf16 v[96:111], v[204:207], v[44:47], v[96:111]
    s_waitcnt vmcnt(0) lgkmcnt(0)
    v_mfma_f32_32x32x16_bf16 v[80:95], v[208:211], v[48:51], v[80:95]
    s_barrier
    ds_read_b128 v[224:227], v6 offset:0
    ds_read_b64_tr_b16 v[16:17], v12 offset:16384
    ds_read_b64_tr_b16 v[18:19], v12 offset:16896
    ds_read_b64_tr_b16 v[20:21], v13 offset:16384
    v_dot2_f32_bf16 v0, v208, v112, v0
    v_dot2_f32_bf16 v0, v209, v113, v0
    v_dot2_f32_bf16 v0, v210, v114, v0
    v_dot2_f32_bf16 v0, v211, v115, v0
    v_mfma_f32_32x32x16_bf16 v[96:111], v[208:211], v[52:55], v[96:111]
    ds_read_b64_tr_b16 v[22:23], v13 offset:16896
    ds_read_b128 v[228:231], v7 offset:0
    ds_read_b64_tr_b16 v[24:25], v12 offset:18432
    ds_read_b64_tr_b16 v[26:27], v12 offset:18944
    v_dot2_f32_bf16 v0, v212, v116, v0
    v_dot2_f32_bf16 v0, v213, v117, v0
    v_dot2_f32_bf16 v0, v214, v118, v0
    v_dot2_f32_bf16 v0, v215, v119, v0
    v_mfma_f32_32x32x16_bf16 v[80:95], v[212:215], v[56:59], v[80:95]
    ds_read_b64_tr_b16 v[28:29], v13 offset:18432
    ds_read_b64_tr_b16 v[30:31], v13 offset:18944
    ds_read_b128 v[232:235], v8 offset:0
    ds_read_b64_tr_b16 v[32:33], v12 offset:20480
    v_dot2_f32_bf16 v0, v216, v120, v0
    v_dot2_f32_bf16 v0, v217, v121, v0
    v_dot2_f32_bf16 v0, v218, v122, v0
    v_dot2_f32_bf16 v0, v219, v123, v0
    v_mfma_f32_32x32x16_bf16 v[96:111], v[212:215], v[60:63], v[96:111]
    ds_read_b64_tr_b16 v[34:35], v12 offset:20992
    ds_read_b64_tr_b16 v[36:37], v13 offset:20480
    ds_read_b64_tr_b16 v[38:39], v13 offset:20992
    ds_read_b128 v[236:239], v9 offset:0
    v_dot2_f32_bf16 v0, v220, v124, v0
    v_dot2_f32_bf16 v0, v221, v125, v0
    v_dot2_f32_bf16 v0, v222, v126, v0
    v_dot2_f32_bf16 v0, v223, v127, v0
    v_mfma_f32_32x32x16_bf16 v[80:95], v[216:219], v[64:67], v[80:95]
    ds_read_b64_tr_b16 v[40:41], v12 offset:22528
    ds_read_b64_tr_b16 v[42:43], v12 offset:23040
    ds_read_b64_tr_b16 v[44:45], v13 offset:22528
    ds_read_b64_tr_b16 v[46:47], v13 offset:23040
    ds_read_b128 v[112:115], v15 offset:768
    ds_read_b128 v[116:119], v15 offset:800
    ds_read_b128 v[120:123], v15 offset:832
    ds_read_b128 v[124:127], v15 offset:864
    v_mfma_f32_32x32x16_bf16 v[96:111], v[216:219], v[68:71], v[96:111]
    v_mfma_f32_32x32x16_bf16 v[80:95], v[220:223], v[72:75], v[80:95]
    v_mfma_f32_32x32x16_bf16 v[96:111], v[220:223], v[76:79], v[96:111]
    s_waitcnt lgkmcnt(0)
    v_mfma_f32_32x32x16_bf16 v[80:95], v[224:227], v[16:19], v[80:95]
    s_barrier
    ds_read_b128 v[240:243], v6 offset:32768
    ds_read_b64_tr_b16 v[48:49], v12 offset:49152
    ds_read_b64_tr_b16 v[50:51], v12 offset:49664
    ds_read_b64_tr_b16 v[52:53], v13 offset:49152
    v_dot2_f32_bf16 v0, v224, v112, v0
    v_dot2_f32_bf16 v0, v225, v113, v0
    v_dot2_f32_bf16 v0, v226, v114, v0
    v_dot2_f32_bf16 v0, v227, v115, v0
    v_mfma_f32_32x32x16_bf16 v[96:111], v[224:227], v[20:23], v[96:111]
    ds_read_b64_tr_b16 v[54:55], v13 offset:49664
    ds_read_b128 v[244:247], v7 offset:32768
    ds_read_b64_tr_b16 v[56:57], v12 offset:51200
    ds_read_b64_tr_b16 v[58:59], v12 offset:51712
    v_dot2_f32_bf16 v0, v228, v116, v0
    v_dot2_f32_bf16 v0, v229, v117, v0
    v_dot2_f32_bf16 v0, v230, v118, v0
    v_dot2_f32_bf16 v0, v231, v119, v0
    v_mfma_f32_32x32x16_bf16 v[80:95], v[228:231], v[24:27], v[80:95]
    ds_read_b64_tr_b16 v[60:61], v13 offset:51200
    ds_read_b64_tr_b16 v[62:63], v13 offset:51712
    ds_read_b128 v[248:251], v8 offset:32768
    ds_read_b64_tr_b16 v[64:65], v12 offset:53248
    v_dot2_f32_bf16 v0, v232, v120, v0
    v_dot2_f32_bf16 v0, v233, v121, v0
    v_dot2_f32_bf16 v0, v234, v122, v0
    v_dot2_f32_bf16 v0, v235, v123, v0
    v_mfma_f32_32x32x16_bf16 v[96:111], v[228:231], v[28:31], v[96:111]
    ds_read_b64_tr_b16 v[66:67], v12 offset:53760
    ds_read_b64_tr_b16 v[68:69], v13 offset:53248
    ds_read_b64_tr_b16 v[70:71], v13 offset:53760
    ds_read_b128 v[252:255], v9 offset:32768
    v_dot2_f32_bf16 v0, v236, v124, v0
    v_dot2_f32_bf16 v0, v237, v125, v0
    v_dot2_f32_bf16 v0, v238, v126, v0
    v_dot2_f32_bf16 v0, v239, v127, v0
    v_mfma_f32_32x32x16_bf16 v[80:95], v[232:235], v[32:35], v[80:95]
    ds_read_b64_tr_b16 v[72:73], v12 offset:55296
    ds_read_b64_tr_b16 v[74:75], v12 offset:55808
    ds_read_b64_tr_b16 v[76:77], v13 offset:55296
    ds_read_b64_tr_b16 v[78:79], v13 offset:55808
    ds_read_b128 v[112:115], v15 offset:896
    ds_read_b128 v[116:119], v15 offset:928
    ds_read_b128 v[120:123], v15 offset:960
    ds_read_b128 v[124:127], v15 offset:992
    v_mfma_f32_32x32x16_bf16 v[96:111], v[232:235], v[36:39], v[96:111]
    v_mfma_f32_32x32x16_bf16 v[80:95], v[236:239], v[40:43], v[80:95]
    v_mfma_f32_32x32x16_bf16 v[96:111], v[236:239], v[44:47], v[96:111]
    s_waitcnt lgkmcnt(0)
    v_mfma_f32_32x32x16_bf16 v[80:95], v[240:243], v[48:51], v[80:95]
    s_barrier
    ds_read_b64_tr_b16 v[16:17], v10 offset:24576
    ds_read_b64_tr_b16 v[18:19], v10 offset:25088
    ds_read_b64_tr_b16 v[20:21], v11 offset:24576
    ds_read_b64_tr_b16 v[22:23], v11 offset:25088
    v_dot2_f32_bf16 v0, v240, v112, v0
    v_dot2_f32_bf16 v0, v241, v113, v0
    v_dot2_f32_bf16 v0, v242, v114, v0
    v_dot2_f32_bf16 v0, v243, v115, v0
    v_mfma_f32_32x32x16_bf16 v[96:111], v[240:243], v[52:55], v[96:111]
    ds_read_b64_tr_b16 v[24:25], v10 offset:26624
    ds_read_b64_tr_b16 v[26:27], v10 offset:27136
    ds_read_b64_tr_b16 v[28:29], v11 offset:26624
    ds_read_b64_tr_b16 v[30:31], v11 offset:27136
    v_dot2_f32_bf16 v0, v244, v116, v0
    v_dot2_f32_bf16 v0, v245, v117, v0
    v_dot2_f32_bf16 v0, v246, v118, v0
    v_dot2_f32_bf16 v0, v247, v119, v0
    v_mfma_f32_32x32x16_bf16 v[80:95], v[244:247], v[56:59], v[80:95]
    ds_read_b64_tr_b16 v[32:33], v10 offset:28672
    ds_read_b64_tr_b16 v[34:35], v10 offset:29184
    ds_read_b64_tr_b16 v[36:37], v11 offset:28672
    ds_read_b64_tr_b16 v[38:39], v11 offset:29184
    v_dot2_f32_bf16 v0, v248, v120, v0
    v_dot2_f32_bf16 v0, v249, v121, v0
    v_dot2_f32_bf16 v0, v250, v122, v0
    v_dot2_f32_bf16 v0, v251, v123, v0
    v_mfma_f32_32x32x16_bf16 v[96:111], v[244:247], v[60:63], v[96:111]
    ds_read_b64_tr_b16 v[40:41], v10 offset:30720
    ds_read_b64_tr_b16 v[42:43], v10 offset:31232
    ds_read_b64_tr_b16 v[44:45], v11 offset:30720
    ds_read_b64_tr_b16 v[46:47], v11 offset:31232
    v_dot2_f32_bf16 v0, v252, v124, v0
    v_dot2_f32_bf16 v0, v253, v125, v0
    v_dot2_f32_bf16 v0, v254, v126, v0
    v_dot2_f32_bf16 v0, v255, v127, v0
    v_mfma_f32_32x32x16_bf16 v[80:95], v[248:251], v[64:67], v[80:95]
    v_and_b32 v2, 0x33, v1
    v_bfe_u32 v3, v1, 2, 1
    v_lshl_or_b32 v2, v3, 3, v2
    v_bfe_u32 v3, v1, 3, 1
    v_lshl_or_b32 v2, v3, 2, v2
    v_mfma_f32_32x32x16_bf16 v[96:111], v[248:251], v[68:71], v[96:111]
    v_lshlrev_b32 v2, 4, v2
    v_mov_b32 v6, s69
    v_cmp_gt_u32 vcc, 4, v6
    v_and_b32 v3, 15, v1
    v_mfma_f32_32x32x16_bf16 v[80:95], v[252:255], v[72:75], v[80:95]
    v_lshlrev_b32 v3, 4, v3
    v_cndmask_b32 v4, v14, v2, vcc
    v_cndmask_b32 v5, v2, v14, vcc
    v_lshrrev_b32 v2, 5, v1
    v_mfma_f32_32x32x16_bf16 v[96:111], v[252:255], v[76:79], v[96:111]
    v_lshl_add_u32 v3, v2, 8, v3
    v_bfe_u32 v2, v1, 4, 1
    v_lshl_add_u32 v3, v2, 17, v3
    v_add_u32 v3, 1024, v3
    s_nop 6
    v_cvt_pk_bf16_f32 v48, v80, v81
    v_cvt_pk_bf16_f32 v49, v82, v83
    v_cvt_pk_bf16_f32 v50, v84, v85
    v_cvt_pk_bf16_f32 v51, v86, v87
    buffer_store_dwordx4 v[48:51], v3, s[36:39], s28 offen offset:0 sc1
    v_cvt_pk_bf16_f32 v52, v88, v89
    v_cvt_pk_bf16_f32 v53, v90, v91
    v_cvt_pk_bf16_f32 v54, v92, v93
    v_cvt_pk_bf16_f32 v55, v94, v95
    buffer_store_dwordx4 v[52:55], v3, s[36:39], s28 offen offset:512 sc1
    v_cvt_pk_bf16_f32 v56, v96, v97
    v_cvt_pk_bf16_f32 v57, v98, v99
    v_cvt_pk_bf16_f32 v58, v100, v101
    v_cvt_pk_bf16_f32 v59, v102, v103
    buffer_store_dwordx4 v[56:59], v3, s[36:39], s29 offen offset:0 sc1
    v_cvt_pk_bf16_f32 v60, v104, v105
    v_cvt_pk_bf16_f32 v61, v106, v107
    v_cvt_pk_bf16_f32 v62, v108, v109
    v_cvt_pk_bf16_f32 v63, v110, v111
    buffer_store_dwordx4 v[60:63], v3, s[36:39], s29 offen offset:512 sc1
    s_nop 1
    v_and_b32 v115, 15, v1
    v_mul_u32_u24 v115, 16, v115
    s_cmp_lg_u32 s56, 0
    s_cbranch_scc1 L_noipv
    buffer_load_dword v114, v115, s[48:51], 0 offen sc1
L_noipv:
    s_mov_b32 s34, 0
    s_waitcnt lgkmcnt(0)
    v_mfma_f32_32x32x16_bf16 v[80:95], v[16:19], v[128:131], 0
    ds_read_b64_tr_b16 v[48:49], v12 offset:57344
    ds_read_b64_tr_b16 v[50:51], v12 offset:57856
    ds_read_b64_tr_b16 v[52:53], v13 offset:57344
    ds_read_b64_tr_b16 v[54:55], v13 offset:57856
    v_mov_b32 v113, v0
    v_and_b32 v119, 31, v1
    v_mfma_f32_32x32x16_bf16 v[96:111], v[20:23], v[128:131], 0
    ds_read_b64_tr_b16 v[56:57], v12 offset:59392
    ds_read_b64_tr_b16 v[58:59], v12 offset:59904
    ds_read_b64_tr_b16 v[60:61], v13 offset:59392
    ds_read_b64_tr_b16 v[62:63], v13 offset:59904
    s_lshl_b32 s62, s56, 7
    v_permlane32_swap_b32 v0, v113
    v_mfma_f32_32x32x16_bf16 v[80:95], v[24:27], v[132:135], v[80:95]
    ds_read_b64_tr_b16 v[64:65], v12 offset:61440
    ds_read_b64_tr_b16 v[66:67], v12 offset:61952
    ds_read_b64_tr_b16 v[68:69], v13 offset:61440
    ds_read_b64_tr_b16 v[70:71], v13 offset:61952
    v_add_f32 v113, v0, v113
    v_mul_f32 v113, 0xbfb8aa3b, v113
    v_mfma_f32_32x32x16_bf16 v[96:111], v[28:31], v[132:135], v[96:111]
    ds_read_b64_tr_b16 v[72:73], v12 offset:63488
    ds_read_b64_tr_b16 v[74:75], v12 offset:64000
    ds_read_b64_tr_b16 v[76:77], v13 offset:63488
    ds_read_b64_tr_b16 v[78:79], v13 offset:64000
    v_exp_f32 v113, v113
    s_add_u32 s62, s62, 29696
    v_mfma_f32_32x32x16_bf16 v[80:95], v[32:35], v[136:139], v[80:95]
    v_add_f32 v113, 1.0, v113
    v_rcp_f32 v113, v113
    v_mfma_f32_32x32x16_bf16 v[96:111], v[36:39], v[136:139], v[96:111]
    v_lshl_add_u32 v119, v119, 2, s62
    ds_write_b32 v119, v113
    v_mfma_f32_32x32x16_bf16 v[80:95], v[40:43], v[140:143], v[80:95]
    v_mfma_f32_32x32x16_bf16 v[96:111], v[44:47], v[140:143], v[96:111]
    s_waitcnt lgkmcnt(0)
    v_mfma_f32_32x32x16_bf16 v[80:95], v[48:51], v[144:147], v[80:95]
    s_barrier
    ds_read_b64_tr_b16 v[16:17], v10 offset:0
    ds_read_b64_tr_b16 v[18:19], v10 offset:512
    ds_read_b64_tr_b16 v[20:21], v11 offset:0
    ds_read_b64_tr_b16 v[22:23], v11 offset:512
    s_lshl_b32 s20, s57, 17
    s_and_b32 s4, s56, 1
    v_mfma_f32_32x32x16_bf16 v[96:111], v[52:55], v[144:147], v[96:111]
    ds_read_b64_tr_b16 v[24:25], v10 offset:2048
    ds_read_b64_tr_b16 v[26:27], v10 offset:2560
    ds_read_b64_tr_b16 v[28:29], v11 offset:2048
    ds_read_b64_tr_b16 v[30:31], v11 offset:2560
    s_lshl_b32 s4, s4, 16
    v_mfma_f32_32x32x16_bf16 v[80:95], v[56:59], v[148:151], v[80:95]
    ds_read_b64_tr_b16 v[32:33], v10 offset:4096
    ds_read_b64_tr_b16 v[34:35], v10 offset:4608
    ds_read_b64_tr_b16 v[36:37], v11 offset:4096
    ds_read_b64_tr_b16 v[38:39], v11 offset:4608
    s_add_u32 s20, s20, s4
    v_mfma_f32_32x32x16_bf16 v[96:111], v[60:63], v[148:151], v[96:111]
    ds_read_b64_tr_b16 v[40:41], v10 offset:6144
    ds_read_b64_tr_b16 v[42:43], v10 offset:6656
    ds_read_b64_tr_b16 v[44:45], v11 offset:6144
    ds_read_b64_tr_b16 v[46:47], v11 offset:6656
    s_lshr_b32 s4, s56, 1
    v_mfma_f32_32x32x16_bf16 v[80:95], v[64:67], v[152:155], v[80:95]
    s_lshl_b32 s4, s4, 13
    v_mfma_f32_32x32x16_bf16 v[96:111], v[68:71], v[152:155], v[96:111]
    s_add_u32 s20, s20, s4
    v_mfma_f32_32x32x16_bf16 v[80:95], v[72:75], v[156:159], v[80:95]
    s_add_u32 s20, s20, 0xc00000
    v_mfma_f32_32x32x16_bf16 v[96:111], v[76:79], v[156:159], v[96:111]
    v_lshrrev_b32 v116, 5, v1
    s_waitcnt lgkmcnt(0)
    v_mfma_f32_32x32x16_bf16 v[80:95], v[16:19], v[160:163], v[80:95]
    ds_read_b64_tr_b16 v[48:49], v10 offset:8192
    ds_read_b64_tr_b16 v[50:51], v10 offset:8704
    ds_read_b64_tr_b16 v[52:53], v11 offset:8192
    ds_read_b64_tr_b16 v[54:55], v11 offset:8704
    v_bfe_u32 v117, v1, 2, 2
    v_mfma_f32_32x32x16_bf16 v[96:111], v[20:23], v[160:163], v[96:111]
    ds_read_b64_tr_b16 v[56:57], v10 offset:10240
    ds_read_b64_tr_b16 v[58:59], v10 offset:10752
    ds_read_b64_tr_b16 v[60:61], v11 offset:10240
    ds_read_b64_tr_b16 v[62:63], v11 offset:10752
    v_lshl_add_u32 v8, v116, 2, v117
    v_mfma_f32_32x32x16_bf16 v[80:95], v[24:27], v[164:167], v[80:95]
    ds_read_b64_tr_b16 v[64:65], v10 offset:12288
    ds_read_b64_tr_b16 v[66:67], v10 offset:12800
    ds_read_b64_tr_b16 v[68:69], v11 offset:12288
    ds_read_b64_tr_b16 v[70:71], v11 offset:12800
    v_lshlrev_b32 v8, 7, v8
    v_mfma_f32_32x32x16_bf16 v[96:111], v[28:31], v[164:167], v[96:111]
    ds_read_b64_tr_b16 v[72:73], v10 offset:14336
    ds_read_b64_tr_b16 v[74:75], v10 offset:14848
    ds_read_b64_tr_b16 v[76:77], v11 offset:14336
    ds_read_b64_tr_b16 v[78:79], v11 offset:14848
    v_bfe_u32 v116, v1, 4, 1
    v_mfma_f32_32x32x16_bf16 v[80:95], v[32:35], v[168:171], v[80:95]
    v_lshlrev_b32 v116, 1, v116
    v_mfma_f32_32x32x16_bf16 v[96:111], v[36:39], v[168:171], v[96:111]
    v_bfe_u32 v117, v1, 1, 1
    v_mfma_f32_32x32x16_bf16 v[80:95], v[40:43], v[172:175], v[80:95]
    v_add_u32 v116, v116, v117
    v_mfma_f32_32x32x16_bf16 v[96:111], v[44:47], v[172:175], v[96:111]
    v_bfe_u32 v117, v1, 3, 1
    s_waitcnt lgkmcnt(0)
    v_mfma_f32_32x32x16_bf16 v[80:95], v[48:51], v[176:179], v[80:95]
    s_barrier
    s_and_b32 s62, s69, 1
    s_lshl_b32 s62, s62, 1
    s_and_b32 s63, s56, 1
    s_add_u32 s62, s62, s63
    s_lshl_b32 s62, s62, 7
    s_add_u32 s62, s62, 29696
    v_and_b32 v118, 31, v1
    v_lshl_add_u32 v118, v118, 2, s62
    ds_read_b32 v112, v118
    ds_read_b64_tr_b16 v[16:17], v10 offset:16384
    ds_read_b64_tr_b16 v[18:19], v10 offset:16896
    ds_read_b64_tr_b16 v[20:21], v11 offset:16384
    ds_read_b64_tr_b16 v[22:23], v11 offset:16896
    v_lshl_or_b32 v116, v117, 2, v116
    v_lshl_add_u32 v8, v116, 4, v8
    v_mfma_f32_32x32x16_bf16 v[96:111], v[52:55], v[176:179], v[96:111]
    ds_read_b64_tr_b16 v[24:25], v10 offset:18432
    ds_read_b64_tr_b16 v[26:27], v10 offset:18944
    ds_read_b64_tr_b16 v[28:29], v11 offset:18432
    ds_read_b64_tr_b16 v[30:31], v11 offset:18944
    v_and_b32 v116, 1, v1
    v_mfma_f32_32x32x16_bf16 v[80:95], v[56:59], v[180:183], v[80:95]
    ds_read_b64_tr_b16 v[32:33], v10 offset:20480
    ds_read_b64_tr_b16 v[34:35], v10 offset:20992
    ds_read_b64_tr_b16 v[36:37], v11 offset:20480
    ds_read_b64_tr_b16 v[38:39], v11 offset:20992
    v_lshl_add_u32 v8, v116, 3, v8
    v_mfma_f32_32x32x16_bf16 v[96:111], v[60:63], v[180:183], v[96:111]
    ds_read_b64_tr_b16 v[40:41], v10 offset:22528
    ds_read_b64_tr_b16 v[42:43], v10 offset:23040
    ds_read_b64_tr_b16 v[44:45], v11 offset:22528
    ds_read_b64_tr_b16 v[46:47], v11 offset:23040
    s_lshr_b32 s4, s56, 1
    v_mfma_f32_32x32x16_bf16 v[80:95], v[64:67], v[184:187], v[80:95]
    s_lshl_b32 s4, s4, 14
    v_mfma_f32_32x32x16_bf16 v[96:111], v[68:71], v[184:187], v[96:111]
    s_add_u32 s4, s4, 65536
    v_mfma_f32_32x32x16_bf16 v[80:95], v[72:75], v[188:191], v[80:95]
    v_add_u32 v8, s4, v8
    v_mfma_f32_32x32x16_bf16 v[96:111], v[76:79], v[188:191], v[96:111]
    v_xor_b32 v9, 64, v8
    s_waitcnt lgkmcnt(0)
    v_mfma_f32_32x32x16_bf16 v[80:95], v[16:19], v[192:195], v[80:95]
    ds_read_b64_tr_b16 v[48:49], v10 offset:32768
    ds_read_b64_tr_b16 v[50:51], v10 offset:33280
    ds_read_b64_tr_b16 v[52:53], v11 offset:32768
    ds_read_b64_tr_b16 v[54:55], v11 offset:33280
    s_lshr_b32 s4, s56, 1
    v_mfma_f32_32x32x16_bf16 v[96:111], v[20:23], v[192:195], v[96:111]
    ds_read_b64_tr_b16 v[56:57], v10 offset:34816
    ds_read_b64_tr_b16 v[58:59], v10 offset:35328
    ds_read_b64_tr_b16 v[60:61], v11 offset:34816
    ds_read_b64_tr_b16 v[62:63], v11 offset:35328
    s_mul_i32 s4, s4, 17408
    v_mfma_f32_32x32x16_bf16 v[80:95], v[24:27], v[196:199], v[80:95]
    ds_read_b64_tr_b16 v[64:65], v10 offset:36864
    ds_read_b64_tr_b16 v[66:67], v10 offset:37376
    ds_read_b64_tr_b16 v[68:69], v11 offset:36864
    ds_read_b64_tr_b16 v[70:71], v11 offset:37376
    s_and_b32 s5, s56, 1
    v_mfma_f32_32x32x16_bf16 v[96:111], v[28:31], v[196:199], v[96:111]
    ds_read_b64_tr_b16 v[72:73], v10 offset:38912
    ds_read_b64_tr_b16 v[74:75], v10 offset:39424
    ds_read_b64_tr_b16 v[76:77], v11 offset:38912
    ds_read_b64_tr_b16 v[78:79], v11 offset:39424
    s_mul_i32 s5, s5, 8704
    v_mfma_f32_32x32x16_bf16 v[80:95], v[32:35], v[200:203], v[80:95]
    s_add_u32 s4, s4, s5
    v_mfma_f32_32x32x16_bf16 v[96:111], v[36:39], v[200:203], v[96:111]
    s_add_u32 s4, s4, 65536
    v_mfma_f32_32x32x16_bf16 v[80:95], v[40:43], v[204:207], v[80:95]
    v_add_u32 v2, s4, v14
    v_mfma_f32_32x32x16_bf16 v[96:111], v[44:47], v[204:207], v[96:111]
    v_and_b32 v116, 7, v1
    s_waitcnt lgkmcnt(0)
    v_mfma_f32_32x32x16_bf16 v[80:95], v[48:51], v[208:211], v[80:95]
    s_waitcnt vmcnt(0)
    s_cmp_lg_u32 s56, 0
    s_cbranch_scc1 L_noinitchkv
    s_mov_b32 s65, 131072
    s_branch L_chk2
L_spin2:
    buffer_load_dword v114, v115, s[48:51], 0 offen sc1
L_chk2:
    s_waitcnt vmcnt(0)
    v_cmp_eq_u32 vcc, 1, v114
    s_sub_u32 s65, s65, 1
    s_cbranch_scc1 L_ok2
    s_cmp_eq_u64 vcc, -1
    s_cbranch_scc0 L_spin2
L_ok2:
L_noinitchkv:
    s_barrier
    s_cmp_lg_u32 s56, 0
    s_cbranch_scc1 L_nopub1v
    v_mov_b32 v114, 1
    s_lshl_b32 s62, s2, 7
    s_add_u32 s62, s62, 0x1000000
    s_mov_b64 exec, 1
    buffer_store_dword v114, v14, s[36:39], s62 offen sc1
    s_mov_b64 exec, -1
L_nopub1v:
    ds_read_b64_tr_b16 v[16:17], v10 offset:40960
    ds_read_b64_tr_b16 v[18:19], v10 offset:41472
    ds_read_b64_tr_b16 v[20:21], v11 offset:40960
    ds_read_b64_tr_b16 v[22:23], v11 offset:41472
    v_lshrrev_b32 v117, 3, v1
    s_and_b32 s4, s56, 3
    v_mfma_f32_32x32x16_bf16 v[96:111], v[52:55], v[208:211], v[96:111]
    ds_read_b64_tr_b16 v[24:25], v10 offset:43008
    ds_read_b64_tr_b16 v[26:27], v10 offset:43520
    ds_read_b64_tr_b16 v[28:29], v11 offset:43008
    ds_read_b64_tr_b16 v[30:31], v11 offset:43520
    s_lshl_b32 s4, s4, 3
    v_mfma_f32_32x32x16_bf16 v[80:95], v[56:59], v[212:215], v[80:95]
    ds_read_b64_tr_b16 v[32:33], v10 offset:45056
    ds_read_b64_tr_b16 v[34:35], v10 offset:45568
    ds_read_b64_tr_b16 v[36:37], v11 offset:45056
    ds_read_b64_tr_b16 v[38:39], v11 offset:45568
    v_add_u32 v117, s4, v117
    v_mfma_f32_32x32x16_bf16 v[96:111], v[60:63], v[212:215], v[96:111]
    ds_read_b64_tr_b16 v[40:41], v10 offset:47104
    ds_read_b64_tr_b16 v[42:43], v10 offset:47616
    ds_read_b64_tr_b16 v[44:45], v11 offset:47104
    ds_read_b64_tr_b16 v[46:47], v11 offset:47616
    v_mul_u32_u24 v7, 1088, v116
    v_mfma_f32_32x32x16_bf16 v[80:95], v[64:67], v[216:219], v[80:95]
    v_lshl_add_u32 v7, v117, 4, v7
    v_mfma_f32_32x32x16_bf16 v[96:111], v[68:71], v[216:219], v[96:111]
    s_lshr_b32 s4, s56, 2
    v_mfma_f32_32x32x16_bf16 v[80:95], v[72:75], v[220:223], v[80:95]
    s_mul_i32 s5, s4, 8704
    v_mfma_f32_32x32x16_bf16 v[96:111], v[76:79], v[220:223], v[96:111]
    s_add_u32 s5, s5, 65536
    s_waitcnt lgkmcnt(0)
    v_mfma_f32_32x32x16_bf16 v[80:95], v[16:19], v[224:227], v[80:95]
    ds_read_b64_tr_b16 v[48:49], v10 offset:49152
    ds_read_b64_tr_b16 v[50:51], v10 offset:49664
    ds_read_b64_tr_b16 v[52:53], v11 offset:49152
    ds_read_b64_tr_b16 v[54:55], v11 offset:49664
    v_add_u32 v7, s5, v7
    v_mfma_f32_32x32x16_bf16 v[96:111], v[20:23], v[224:227], v[96:111]
    ds_read_b64_tr_b16 v[56:57], v10 offset:51200
    ds_read_b64_tr_b16 v[58:59], v10 offset:51712
    ds_read_b64_tr_b16 v[60:61], v11 offset:51200
    ds_read_b64_tr_b16 v[62:63], v11 offset:51712
    v_lshlrev_b32 v6, 10, v117
    v_mfma_f32_32x32x16_bf16 v[80:95], v[24:27], v[228:231], v[80:95]
    ds_read_b64_tr_b16 v[64:65], v10 offset:53248
    ds_read_b64_tr_b16 v[66:67], v10 offset:53760
    ds_read_b64_tr_b16 v[68:69], v11 offset:53248
    ds_read_b64_tr_b16 v[70:71], v11 offset:53760
    v_lshl_add_u32 v6, v116, 4, v6
    v_mfma_f32_32x32x16_bf16 v[96:111], v[28:31], v[228:231], v[96:111]
    ds_read_b64_tr_b16 v[72:73], v10 offset:55296
    ds_read_b64_tr_b16 v[74:75], v10 offset:55808
    ds_read_b64_tr_b16 v[76:77], v11 offset:55296
    ds_read_b64_tr_b16 v[78:79], v11 offset:55808
    s_lshl_b32 s4, s4, 15
    v_mfma_f32_32x32x16_bf16 v[80:95], v[32:35], v[232:235], v[80:95]
    s_lshl_b32 s5, s57, 16
    v_mfma_f32_32x32x16_bf16 v[96:111], v[36:39], v[232:235], v[96:111]
    s_add_u32 s4, s4, s5
    v_mfma_f32_32x32x16_bf16 v[80:95], v[40:43], v[236:239], v[80:95]
    s_lshl_b32 s5, s58, 7
    v_mfma_f32_32x32x16_bf16 v[96:111], v[44:47], v[236:239], v[96:111]
    s_add_u32 s33, s4, s5
    s_waitcnt lgkmcnt(0)
    v_mfma_f32_32x32x16_bf16 v[80:95], v[48:51], v[240:243], v[80:95]
    ds_read_b64_tr_b16 v[16:17], v10 offset:57344
    ds_read_b64_tr_b16 v[18:19], v10 offset:57856
    ds_read_b64_tr_b16 v[20:21], v11 offset:57344
    ds_read_b64_tr_b16 v[22:23], v11 offset:57856
    v_mfma_f32_32x32x16_bf16 v[96:111], v[52:55], v[240:243], v[96:111]
    ds_read_b64_tr_b16 v[24:25], v10 offset:59392
    ds_read_b64_tr_b16 v[26:27], v10 offset:59904
    ds_read_b64_tr_b16 v[28:29], v11 offset:59392
    ds_read_b64_tr_b16 v[30:31], v11 offset:59904
    v_mfma_f32_32x32x16_bf16 v[80:95], v[56:59], v[244:247], v[80:95]
    ds_read_b64_tr_b16 v[32:33], v10 offset:61440
    ds_read_b64_tr_b16 v[34:35], v10 offset:61952
    ds_read_b64_tr_b16 v[36:37], v11 offset:61440
    ds_read_b64_tr_b16 v[38:39], v11 offset:61952
    v_mfma_f32_32x32x16_bf16 v[96:111], v[60:63], v[244:247], v[96:111]
    ds_read_b64_tr_b16 v[40:41], v10 offset:63488
    ds_read_b64_tr_b16 v[42:43], v10 offset:64000
    ds_read_b64_tr_b16 v[44:45], v11 offset:63488
    ds_read_b64_tr_b16 v[46:47], v11 offset:64000
    v_mfma_f32_32x32x16_bf16 v[80:95], v[64:67], v[248:251], v[80:95]
    v_mfma_f32_32x32x16_bf16 v[96:111], v[68:71], v[248:251], v[96:111]
    v_mfma_f32_32x32x16_bf16 v[80:95], v[72:75], v[252:255], v[80:95]
    v_mfma_f32_32x32x16_bf16 v[96:111], v[76:79], v[252:255], v[96:111]
    s_nop 10
    v_cvt_pk_bf16_f32 v48, v80, v81
    v_cvt_pk_bf16_f32 v49, v82, v83
    v_cvt_pk_bf16_f32 v50, v84, v85
    v_cvt_pk_bf16_f32 v51, v86, v87
    buffer_store_dwordx4 v[48:51], v4, s[36:39], s24 offen sc1
    s_add_u32 s24, s24, s25
    v_cvt_pk_bf16_f32 v52, v88, v89
    v_cvt_pk_bf16_f32 v53, v90, v91
    v_cvt_pk_bf16_f32 v54, v92, v93
    v_cvt_pk_bf16_f32 v55, v94, v95
    buffer_store_dwordx4 v[52:55], v4, s[36:39], s24 offen sc1
    s_add_u32 s24, s24, s25
    v_cvt_pk_bf16_f32 v56, v96, v97
    v_cvt_pk_bf16_f32 v57, v98, v99
    v_cvt_pk_bf16_f32 v58, v100, v101
    v_cvt_pk_bf16_f32 v59, v102, v103
    buffer_store_dwordx4 v[56:59], v4, s[36:39], s24 offen sc1
    s_add_u32 s24, s24, s25
    v_cvt_pk_bf16_f32 v60, v104, v105
    v_cvt_pk_bf16_f32 v61, v106, v107
    v_cvt_pk_bf16_f32 v62, v108, v109
    v_cvt_pk_bf16_f32 v63, v110, v111
    buffer_store_dwordx4 v[60:63], v4, s[36:39], s24 offen sc1
    s_add_u32 s24, s24, s25
    s_nop 1
    s_branch L_p3
L_p12q:
    s_barrier
    ds_read_b128 v[128:131], v2 offset:0
    ds_read_b64_tr_b16 v[16:17], v10 offset:16384
    ds_read_b64_tr_b16 v[18:19], v10 offset:16896
    ds_read_b64_tr_b16 v[20:21], v11 offset:16384
    ds_read_b64_tr_b16 v[22:23], v11 offset:16896
    ds_read_b128 v[132:135], v3 offset:0
    ds_read_b64_tr_b16 v[24:25], v10 offset:18432
    ds_read_b64_tr_b16 v[26:27], v10 offset:18944
    ds_read_b64_tr_b16 v[28:29], v11 offset:18432
    ds_read_b64_tr_b16 v[30:31], v11 offset:18944
    ds_read_b128 v[136:139], v4 offset:0
    ds_read_b64_tr_b16 v[32:33], v10 offset:20480
    ds_read_b64_tr_b16 v[34:35], v10 offset:20992
    ds_read_b64_tr_b16 v[36:37], v11 offset:20480
    ds_read_b64_tr_b16 v[38:39], v11 offset:20992
    ds_read_b128 v[140:143], v5 offset:0
    ds_read_b64_tr_b16 v[40:41], v10 offset:22528
    ds_read_b64_tr_b16 v[42:43], v10 offset:23040
    ds_read_b64_tr_b16 v[44:45], v11 offset:22528
    ds_read_b64_tr_b16 v[46:47], v11 offset:23040
    ds_read_b128 v[112:115], v15 offset:0
    ds_read_b128 v[116:119], v15 offset:32
    ds_read_b128 v[120:123], v15 offset:64
    ds_read_b128 v[124:127], v15 offset:96
    s_waitcnt lgkmcnt(0)
    v_mfma_f32_32x32x16_bf16 v[80:95], v[16:19], v[128:131], 0
    s_barrier
    ds_read_b128 v[144:147], v2 offset:32768
    ds_read_b64_tr_b16 v[48:49], v10 offset:49152
    ds_read_b64_tr_b16 v[50:51], v10 offset:49664
    ds_read_b64_tr_b16 v[52:53], v11 offset:49152
    v_dot2_f32_bf16 v0, v128, v112, v0
    v_dot2_f32_bf16 v0, v129, v113, v0
    v_dot2_f32_bf16 v0, v130, v114, v0
    v_dot2_f32_bf16 v0, v131, v115, v0
    v_mfma_f32_32x32x16_bf16 v[96:111], v[20:23], v[128:131], 0
    ds_read_b64_tr_b16 v[54:55], v11 offset:49664
    ds_read_b128 v[148:151], v3 offset:32768
    ds_read_b64_tr_b16 v[56:57], v10 offset:51200
    ds_read_b64_tr_b16 v[58:59], v10 offset:51712
    v_dot2_f32_bf16 v0, v132, v116, v0
    v_dot2_f32_bf16 v0, v133, v117, v0
    v_dot2_f32_bf16 v0, v134, v118, v0
    v_dot2_f32_bf16 v0, v135, v119, v0
    v_mfma_f32_32x32x16_bf16 v[80:95], v[24:27], v[132:135], v[80:95]
    ds_read_b64_tr_b16 v[60:61], v11 offset:51200
    ds_read_b64_tr_b16 v[62:63], v11 offset:51712
    ds_read_b128 v[152:155], v4 offset:32768
    ds_read_b64_tr_b16 v[64:65], v10 offset:53248
    v_dot2_f32_bf16 v0, v136, v120, v0
    v_dot2_f32_bf16 v0, v137, v121, v0
    v_dot2_f32_bf16 v0, v138, v122, v0
    v_dot2_f32_bf16 v0, v139, v123, v0
    v_mfma_f32_32x32x16_bf16 v[96:111], v[28:31], v[132:135], v[96:111]
    ds_read_b64_tr_b16 v[66:67], v10 offset:53760
    ds_read_b64_tr_b16 v[68:69], v11 offset:53248
    ds_read_b64_tr_b16 v[70:71], v11 offset:53760
    ds_read_b128 v[156:159], v5 offset:32768
    v_dot2_f32_bf16 v0, v140, v124, v0
    v_dot2_f32_bf16 v0, v141, v125, v0
    v_dot2_f32_bf16 v0, v142, v126, v0
    v_dot2_f32_bf16 v0, v143, v127, v0
    v_mfma_f32_32x32x16_bf16 v[80:95], v[32:35], v[136:139], v[80:95]
    ds_read_b64_tr_b16 v[72:73], v10 offset:55296
    ds_read_b64_tr_b16 v[74:75], v10 offset:55808
    ds_read_b64_tr_b16 v[76:77], v11 offset:55296
    ds_read_b64_tr_b16 v[78:79], v11 offset:55808
    ds_read_b128 v[112:115], v15 offset:128
    ds_read_b128 v[116:119], v15 offset:160
    ds_read_b128 v[120:123], v15 offset:192
    ds_read_b128 v[124:127], v15 offset:224
    v_mfma_f32_32x32x16_bf16 v[96:111], v[36:39], v[136:139], v[96:111]
    v_mfma_f32_32x32x16_bf16 v[80:95], v[40:43], v[140:143], v[80:95]
    v_mfma_f32_32x32x16_bf16 v[96:111], v[44:47], v[140:143], v[96:111]
    s_waitcnt lgkmcnt(0)
    v_mfma_f32_32x32x16_bf16 v[80:95], v[48:51], v[144:147], v[80:95]
    s_barrier
    s_cmp_lt_u32 s35, 16
    s_cbranch_scc0 L_noinit2q
    s_mul_i32 s62, s2, 16
    s_waitcnt vmcnt(0)
    s_mov_b64 exec, 1
    buffer_store_dword v254, v14, s[48:51], s62 offen sc1
    s_mov_b64 exec, -1
L_noinit2q:
    ds_read_b128 v[160:163], v6 offset:0
    ds_read_b64_tr_b16 v[16:17], v12 offset:16384
    ds_read_b64_tr_b16 v[18:19], v12 offset:16896
    ds_read_b64_tr_b16 v[20:21], v13 offset:16384
    v_dot2_f32_bf16 v0, v144, v112, v0
    v_dot2_f32_bf16 v0, v145, v113, v0
    v_dot2_f32_bf16 v0, v146, v114, v0
    v_dot2_f32_bf16 v0, v147, v115, v0
    v_mfma_f32_32x32x16_bf16 v[96:111], v[52:55], v[144:147], v[96:111]
    ds_read_b64_tr_b16 v[22:23], v13 offset:16896
    ds_read_b128 v[164:167], v7 offset:0
    ds_read_b64_tr_b16 v[24:25], v12 offset:18432
    ds_read_b64_tr_b16 v[26:27], v12 offset:18944
    v_dot2_f32_bf16 v0, v148, v116, v0
    v_dot2_f32_bf16 v0, v149, v117, v0
    v_dot2_f32_bf16 v0, v150, v118, v0
    v_dot2_f32_bf16 v0, v151, v119, v0
    v_mfma_f32_32x32x16_bf16 v[80:95], v[56:59], v[148:151], v[80:95]
    ds_read_b64_tr_b16 v[28:29], v13 offset:18432
    ds_read_b64_tr_b16 v[30:31], v13 offset:18944
    ds_read_b128 v[168:171], v8 offset:0
    ds_read_b64_tr_b16 v[32:33], v12 offset:20480
    v_dot2_f32_bf16 v0, v152, v120, v0
    v_dot2_f32_bf16 v0, v153, v121, v0
    v_dot2_f32_bf16 v0, v154, v122, v0
    v_dot2_f32_bf16 v0, v155, v123, v0
    v_mfma_f32_32x32x16_bf16 v[96:111], v[60:63], v[148:151], v[96:111]
    ds_read_b64_tr_b16 v[34:35], v12 offset:20992
    ds_read_b64_tr_b16 v[36:37], v13 offset:20480
    ds_read_b64_tr_b16 v[38:39], v13 offset:20992
    ds_read_b128 v[172:175], v9 offset:0
    v_dot2_f32_bf16 v0, v156, v124, v0
    v_dot2_f32_bf16 v0, v157, v125, v0
    v_dot2_f32_bf16 v0, v158, v126, v0
    v_dot2_f32_bf16 v0, v159, v127, v0
    v_mfma_f32_32x32x16_bf16 v[80:95], v[64:67], v[152:155], v[80:95]
    ds_read_b64_tr_b16 v[40:41], v12 offset:22528
    ds_read_b64_tr_b16 v[42:43], v12 offset:23040
    ds_read_b64_tr_b16 v[44:45], v13 offset:22528
    ds_read_b64_tr_b16 v[46:47], v13 offset:23040
    ds_read_b128 v[112:115], v15 offset:256
    ds_read_b128 v[116:119], v15 offset:288
    ds_read_b128 v[120:123], v15 offset:320
    ds_read_b128 v[124:127], v15 offset:352
    v_mfma_f32_32x32x16_bf16 v[96:111], v[68:71], v[152:155], v[96:111]
    v_mfma_f32_32x32x16_bf16 v[80:95], v[72:75], v[156:159], v[80:95]
    v_mfma_f32_32x32x16_bf16 v[96:111], v[76:79], v[156:159], v[96:111]
    s_waitcnt lgkmcnt(0)
    v_mfma_f32_32x32x16_bf16 v[80:95], v[16:19], v[160:163], v[80:95]
    s_barrier
    ds_read_b128 v[176:179], v6 offset:32768
    ds_read_b64_tr_b16 v[48:49], v12 offset:49152
    ds_read_b64_tr_b16 v[50:51], v12 offset:49664
    ds_read_b64_tr_b16 v[52:53], v13 offset:49152
    v_dot2_f32_bf16 v0, v160, v112, v0
    v_dot2_f32_bf16 v0, v161, v113, v0
    v_dot2_f32_bf16 v0, v162, v114, v0
    v_dot2_f32_bf16 v0, v163, v115, v0
    v_mfma_f32_32x32x16_bf16 v[96:111], v[20:23], v[160:163], v[96:111]
    ds_read_b64_tr_b16 v[54:55], v13 offset:49664
    ds_read_b128 v[180:183], v7 offset:32768
    ds_read_b64_tr_b16 v[56:57], v12 offset:51200
    ds_read_b64_tr_b16 v[58:59], v12 offset:51712
    v_dot2_f32_bf16 v0, v164, v116, v0
    v_dot2_f32_bf16 v0, v165, v117, v0
    v_dot2_f32_bf16 v0, v166, v118, v0
    v_dot2_f32_bf16 v0, v167, v119, v0
    v_mfma_f32_32x32x16_bf16 v[80:95], v[24:27], v[164:167], v[80:95]
    ds_read_b64_tr_b16 v[60:61], v13 offset:51200
    ds_read_b64_tr_b16 v[62:63], v13 offset:51712
    ds_read_b128 v[184:187], v8 offset:32768
    ds_read_b64_tr_b16 v[64:65], v12 offset:53248
    v_dot2_f32_bf16 v0, v168, v120, v0
    v_dot2_f32_bf16 v0, v169, v121, v0
    v_dot2_f32_bf16 v0, v170, v122, v0
    v_dot2_f32_bf16 v0, v171, v123, v0
    v_mfma_f32_32x32x16_bf16 v[96:111], v[28:31], v[164:167], v[96:111]
    ds_read_b64_tr_b16 v[66:67], v12 offset:53760
    ds_read_b64_tr_b16 v[68:69], v13 offset:53248
    ds_read_b64_tr_b16 v[70:71], v13 offset:53760
    ds_read_b128 v[188:191], v9 offset:32768
    v_dot2_f32_bf16 v0, v172, v124, v0
    v_dot2_f32_bf16 v0, v173, v125, v0
    v_dot2_f32_bf16 v0, v174, v126, v0
    v_dot2_f32_bf16 v0, v175, v127, v0
    v_mfma_f32_32x32x16_bf16 v[80:95], v[32:35], v[168:171], v[80:95]
    ds_read_b64_tr_b16 v[72:73], v12 offset:55296
    ds_read_b64_tr_b16 v[74:75], v12 offset:55808
    ds_read_b64_tr_b16 v[76:77], v13 offset:55296
    ds_read_b64_tr_b16 v[78:79], v13 offset:55808
    ds_read_b128 v[112:115], v15 offset:384
    ds_read_b128 v[116:119], v15 offset:416
    ds_read_b128 v[120:123], v15 offset:448
    ds_read_b128 v[124:127], v15 offset:480
    v_mfma_f32_32x32x16_bf16 v[96:111], v[36:39], v[168:171], v[96:111]
    v_mfma_f32_32x32x16_bf16 v[80:95], v[40:43], v[172:175], v[80:95]
    v_mfma_f32_32x32x16_bf16 v[96:111], v[44:47], v[172:175], v[96:111]
    s_waitcnt lgkmcnt(0)
    v_mfma_f32_32x32x16_bf16 v[80:95], v[48:51], v[176:179], v[80:95]
    s_barrier
    ds_read_b128 v[192:195], v2 offset:0
    ds_read_b64_tr_b16 v[16:17], v10 offset:16384
    ds_read_b64_tr_b16 v[18:19], v10 offset:16896
    ds_read_b64_tr_b16 v[20:21], v11 offset:16384
    v_dot2_f32_bf16 v0, v176, v112, v0
    v_dot2_f32_bf16 v0, v177, v113, v0
    v_dot2_f32_bf16 v0, v178, v114, v0
    v_dot2_f32_bf16 v0, v179, v115, v0
    v_mfma_f32_32x32x16_bf16 v[96:111], v[52:55], v[176:179], v[96:111]
    ds_read_b64_tr_b16 v[22:23], v11 offset:16896
    ds_read_b128 v[196:199], v3 offset:0
    ds_read_b64_tr_b16 v[24:25], v10 offset:18432
    ds_read_b64_tr_b16 v[26:27], v10 offset:18944
    v_dot2_f32_bf16 v0, v180, v116, v0
    v_dot2_f32_bf16 v0, v181, v117, v0
    v_dot2_f32_bf16 v0, v182, v118, v0
    v_dot2_f32_bf16 v0, v183, v119, v0
    v_mfma_f32_32x32x16_bf16 v[80:95], v[56:59], v[180:183], v[80:95]
    ds_read_b64_tr_b16 v[28:29], v11 offset:18432
    ds_read_b64_tr_b16 v[30:31], v11 offset:18944
    ds_read_b128 v[200:203], v4 offset:0
    ds_read_b64_tr_b16 v[32:33], v10 offset:20480
    v_dot2_f32_bf16 v0, v184, v120, v0
    v_dot2_f32_bf16 v0, v185, v121, v0
    v_dot2_f32_bf16 v0, v186, v122, v0
    v_dot2_f32_bf16 v0, v187, v123, v0
    v_mfma_f32_32x32x16_bf16 v[96:111], v[60:63], v[180:183], v[96:111]
    ds_read_b64_tr_b16 v[34:35], v10 offset:20992
    ds_read_b64_tr_b16 v[36:37], v11 offset:20480
    ds_read_b64_tr_b16 v[38:39], v11 offset:20992
    ds_read_b128 v[204:207], v5 offset:0
    v_dot2_f32_bf16 v0, v188, v124, v0
    v_dot2_f32_bf16 v0, v189, v125, v0
    v_dot2_f32_bf16 v0, v190, v126, v0
    v_dot2_f32_bf16 v0, v191, v127, v0
    v_mfma_f32_32x32x16_bf16 v[80:95], v[64:67], v[184:187], v[80:95]
    ds_read_b64_tr_b16 v[40:41], v10 offset:22528
    ds_read_b64_tr_b16 v[42:43], v10 offset:23040
    ds_read_b64_tr_b16 v[44:45], v11 offset:22528
    ds_read_b64_tr_b16 v[46:47], v11 offset:23040
    ds_read_b128 v[112:115], v15 offset:512
    ds_read_b128 v[116:119], v15 offset:544
    ds_read_b128 v[120:123], v15 offset:576
    ds_read_b128 v[124:127], v15 offset:608
    v_mfma_f32_32x32x16_bf16 v[96:111], v[68:71], v[184:187], v[96:111]
    v_mfma_f32_32x32x16_bf16 v[80:95], v[72:75], v[188:191], v[80:95]
    v_mfma_f32_32x32x16_bf16 v[96:111], v[76:79], v[188:191], v[96:111]
    s_waitcnt lgkmcnt(0)
    v_mfma_f32_32x32x16_bf16 v[80:95], v[16:19], v[192:195], v[80:95]
    s_barrier
    ds_read_b128 v[208:211], v2 offset:32768
    ds_read_b64_tr_b16 v[48:49], v10 offset:49152
    ds_read_b64_tr_b16 v[50:51], v10 offset:49664
    ds_read_b64_tr_b16 v[52:53], v11 offset:49152
    v_dot2_f32_bf16 v0, v192, v112, v0
    v_dot2_f32_bf16 v0, v193, v113, v0
    v_dot2_f32_bf16 v0, v194, v114, v0
    v_dot2_f32_bf16 v0, v195, v115, v0
    v_mfma_f32_32x32x16_bf16 v[96:111], v[20:23], v[192:195], v[96:111]
    ds_read_b64_tr_b16 v[54:55], v11 offset:49664
    ds_read_b128 v[212:215], v3 offset:32768
    ds_read_b64_tr_b16 v[56:57], v10 offset:51200
    ds_read_b64_tr_b16 v[58:59], v10 offset:51712
    v_dot2_f32_bf16 v0, v196, v116, v0
    v_dot2_f32_bf16 v0, v197, v117, v0
    v_dot2_f32_bf16 v0, v198, v118, v0
    v_dot2_f32_bf16 v0, v199, v119, v0
    v_mfma_f32_32x32x16_bf16 v[80:95], v[24:27], v[196:199], v[80:95]
    ds_read_b64_tr_b16 v[60:61], v11 offset:51200
    ds_read_b64_tr_b16 v[62:63], v11 offset:51712
    ds_read_b128 v[216:219], v4 offset:32768
    ds_read_b64_tr_b16 v[64:65], v10 offset:53248
    v_dot2_f32_bf16 v0, v200, v120, v0
    v_dot2_f32_bf16 v0, v201, v121, v0
    v_dot2_f32_bf16 v0, v202, v122, v0
    v_dot2_f32_bf16 v0, v203, v123, v0
    v_mfma_f32_32x32x16_bf16 v[96:111], v[28:31], v[196:199], v[96:111]
    ds_read_b64_tr_b16 v[66:67], v10 offset:53760
    ds_read_b64_tr_b16 v[68:69], v11 offset:53248
    ds_read_b64_tr_b16 v[70:71], v11 offset:53760
    ds_read_b128 v[220:223], v5 offset:32768
    v_dot2_f32_bf16 v0, v204, v124, v0
    v_dot2_f32_bf16 v0, v205, v125, v0
    v_dot2_f32_bf16 v0, v206, v126, v0
    v_dot2_f32_bf16 v0, v207, v127, v0
    v_mfma_f32_32x32x16_bf16 v[80:95], v[32:35], v[200:203], v[80:95]
    ds_read_b64_tr_b16 v[72:73], v10 offset:55296
    ds_read_b64_tr_b16 v[74:75], v10 offset:55808
    ds_read_b64_tr_b16 v[76:77], v11 offset:55296
    ds_read_b64_tr_b16 v[78:79], v11 offset:55808
    ds_read_b128 v[112:115], v15 offset:640
    ds_read_b128 v[116:119], v15 offset:672
    ds_read_b128 v[120:123], v15 offset:704
    ds_read_b128 v[124:127], v15 offset:736
    v_mfma_f32_32x32x16_bf16 v[96:111], v[36:39], v[200:203], v[96:111]
    v_mfma_f32_32x32x16_bf16 v[80:95], v[40:43], v[204:207], v[80:95]
    v_mfma_f32_32x32x16_bf16 v[96:111], v[44:47], v[204:207], v[96:111]
    s_waitcnt vmcnt(0) lgkmcnt(0)
    v_mfma_f32_32x32x16_bf16 v[80:95], v[48:51], v[208:211], v[80:95]
    s_barrier
    ds_read_b128 v[224:227], v6 offset:0
    ds_read_b64_tr_b16 v[16:17], v12 offset:16384
    ds_read_b64_tr_b16 v[18:19], v12 offset:16896
    ds_read_b64_tr_b16 v[20:21], v13 offset:16384
    v_dot2_f32_bf16 v0, v208, v112, v0
    v_dot2_f32_bf16 v0, v209, v113, v0
    v_dot2_f32_bf16 v0, v210, v114, v0
    v_dot2_f32_bf16 v0, v211, v115, v0
    v_mfma_f32_32x32x16_bf16 v[96:111], v[52:55], v[208:211], v[96:111]
    ds_read_b64_tr_b16 v[22:23], v13 offset:16896
    ds_read_b128 v[228:231], v7 offset:0
    ds_read_b64_tr_b16 v[24:25], v12 offset:18432
    ds_read_b64_tr_b16 v[26:27], v12 offset:18944
    v_dot2_f32_bf16 v0, v212, v116, v0
    v_dot2_f32_bf16 v0, v213, v117, v0
    v_dot2_f32_bf16 v0, v214, v118, v0
    v_dot2_f32_bf16 v0, v215, v119, v0
    v_mfma_f32_32x32x16_bf16 v[80:95], v[56:59], v[212:215], v[80:95]
    ds_read_b64_tr_b16 v[28:29], v13 offset:18432
    ds_read_b64_tr_b16 v[30:31], v13 offset:18944
    ds_read_b128 v[232:235], v8 offset:0
    ds_read_b64_tr_b16 v[32:33], v12 offset:20480
    v_dot2_f32_bf16 v0, v216, v120, v0
    v_dot2_f32_bf16 v0, v217, v121, v0
    v_dot2_f32_bf16 v0, v218, v122, v0
    v_dot2_f32_bf16 v0, v219, v123, v0
    v_mfma_f32_32x32x16_bf16 v[96:111], v[60:63], v[212:215], v[96:111]
    ds_read_b64_tr_b16 v[34:35], v12 offset:20992
    ds_read_b64_tr_b16 v[36:37], v13 offset:20480
    ds_read_b64_tr_b16 v[38:39], v13 offset:20992
    ds_read_b128 v[236:239], v9 offset:0
    v_dot2_f32_bf16 v0, v220, v124, v0
    v_dot2_f32_bf16 v0, v221, v125, v0
    v_dot2_f32_bf16 v0, v222, v126, v0
    v_dot2_f32_bf16 v0, v223, v127, v0
    v_mfma_f32_32x32x16_bf16 v[80:95], v[64:67], v[216:219], v[80:95]
    ds_read_b64_tr_b16 v[40:41], v12 offset:22528
    ds_read_b64_tr_b16 v[42:43], v12 offset:23040
    ds_read_b64_tr_b16 v[44:45], v13 offset:22528
    ds_read_b64_tr_b16 v[46:47], v13 offset:23040
    ds_read_b128 v[112:115], v15 offset:768
    ds_read_b128 v[116:119], v15 offset:800
    ds_read_b128 v[120:123], v15 offset:832
    ds_read_b128 v[124:127], v15 offset:864
    v_mfma_f32_32x32x16_bf16 v[96:111], v[68:71], v[216:219], v[96:111]
    v_mfma_f32_32x32x16_bf16 v[80:95], v[72:75], v[220:223], v[80:95]
    v_mfma_f32_32x32x16_bf16 v[96:111], v[76:79], v[220:223], v[96:111]
    s_waitcnt lgkmcnt(0)
    v_mfma_f32_32x32x16_bf16 v[80:95], v[16:19], v[224:227], v[80:95]
    s_barrier
    ds_read_b128 v[240:243], v6 offset:32768
    ds_read_b64_tr_b16 v[48:49], v12 offset:49152
    ds_read_b64_tr_b16 v[50:51], v12 offset:49664
    ds_read_b64_tr_b16 v[52:53], v13 offset:49152
    v_dot2_f32_bf16 v0, v224, v112, v0
    v_dot2_f32_bf16 v0, v225, v113, v0
    v_dot2_f32_bf16 v0, v226, v114, v0
    v_dot2_f32_bf16 v0, v227, v115, v0
    v_mfma_f32_32x32x16_bf16 v[96:111], v[20:23], v[224:227], v[96:111]
    ds_read_b64_tr_b16 v[54:55], v13 offset:49664
    ds_read_b128 v[244:247], v7 offset:32768
    ds_read_b64_tr_b16 v[56:57], v12 offset:51200
    ds_read_b64_tr_b16 v[58:59], v12 offset:51712
    v_dot2_f32_bf16 v0, v228, v116, v0
    v_dot2_f32_bf16 v0, v229, v117, v0
    v_dot2_f32_bf16 v0, v230, v118, v0
    v_dot2_f32_bf16 v0, v231, v119, v0
    v_mfma_f32_32x32x16_bf16 v[80:95], v[24:27], v[228:231], v[80:95]
    ds_read_b64_tr_b16 v[60:61], v13 offset:51200
    ds_read_b64_tr_b16 v[62:63], v13 offset:51712
    ds_read_b128 v[248:251], v8 offset:32768
    ds_read_b64_tr_b16 v[64:65], v12 offset:53248
    v_dot2_f32_bf16 v0, v232, v120, v0
    v_dot2_f32_bf16 v0, v233, v121, v0
    v_dot2_f32_bf16 v0, v234, v122, v0
    v_dot2_f32_bf16 v0, v235, v123, v0
    v_mfma_f32_32x32x16_bf16 v[96:111], v[28:31], v[228:231], v[96:111]
    ds_read_b64_tr_b16 v[66:67], v12 offset:53760
    ds_read_b64_tr_b16 v[68:69], v13 offset:53248
    ds_read_b64_tr_b16 v[70:71], v13 offset:53760
    ds_read_b128 v[252:255], v9 offset:32768
    v_dot2_f32_bf16 v0, v236, v124, v0
    v_dot2_f32_bf16 v0, v237, v125, v0
    v_dot2_f32_bf16 v0, v238, v126, v0
    v_dot2_f32_bf16 v0, v239, v127, v0
    v_mfma_f32_32x32x16_bf16 v[80:95], v[32:35], v[232:235], v[80:95]
    ds_read_b64_tr_b16 v[72:73], v12 offset:55296
    ds_read_b64_tr_b16 v[74:75], v12 offset:55808
    ds_read_b64_tr_b16 v[76:77], v13 offset:55296
    ds_read_b64_tr_b16 v[78:79], v13 offset:55808
    ds_read_b128 v[112:115], v15 offset:896
    ds_read_b128 v[116:119], v15 offset:928
    ds_read_b128 v[120:123], v15 offset:960
    ds_read_b128 v[124:127], v15 offset:992
    v_mfma_f32_32x32x16_bf16 v[96:111], v[36:39], v[232:235], v[96:111]
    v_mfma_f32_32x32x16_bf16 v[80:95], v[40:43], v[236:239], v[80:95]
    v_mfma_f32_32x32x16_bf16 v[96:111], v[44:47], v[236:239], v[96:111]
    s_waitcnt lgkmcnt(0)
    v_mfma_f32_32x32x16_bf16 v[80:95], v[48:51], v[240:243], v[80:95]
    s_barrier
    ds_read_b64_tr_b16 v[16:17], v10 offset:24576
    ds_read_b64_tr_b16 v[18:19], v10 offset:25088
    ds_read_b64_tr_b16 v[20:21], v11 offset:24576
    ds_read_b64_tr_b16 v[22:23], v11 offset:25088
    v_dot2_f32_bf16 v0, v240, v112, v0
    v_dot2_f32_bf16 v0, v241, v113, v0
    v_dot2_f32_bf16 v0, v242, v114, v0
    v_dot2_f32_bf16 v0, v243, v115, v0
    v_mfma_f32_32x32x16_bf16 v[96:111], v[52:55], v[240:243], v[96:111]
    ds_read_b64_tr_b16 v[24:25], v10 offset:26624
    ds_read_b64_tr_b16 v[26:27], v10 offset:27136
    ds_read_b64_tr_b16 v[28:29], v11 offset:26624
    ds_read_b64_tr_b16 v[30:31], v11 offset:27136
    v_dot2_f32_bf16 v0, v244, v116, v0
    v_dot2_f32_bf16 v0, v245, v117, v0
    v_dot2_f32_bf16 v0, v246, v118, v0
    v_dot2_f32_bf16 v0, v247, v119, v0
    v_mfma_f32_32x32x16_bf16 v[80:95], v[56:59], v[244:247], v[80:95]
    ds_read_b64_tr_b16 v[32:33], v10 offset:28672
    ds_read_b64_tr_b16 v[34:35], v10 offset:29184
    ds_read_b64_tr_b16 v[36:37], v11 offset:28672
    ds_read_b64_tr_b16 v[38:39], v11 offset:29184
    v_dot2_f32_bf16 v0, v248, v120, v0
    v_dot2_f32_bf16 v0, v249, v121, v0
    v_dot2_f32_bf16 v0, v250, v122, v0
    v_dot2_f32_bf16 v0, v251, v123, v0
    v_mfma_f32_32x32x16_bf16 v[96:111], v[60:63], v[244:247], v[96:111]
    ds_read_b64_tr_b16 v[40:41], v10 offset:30720
    ds_read_b64_tr_b16 v[42:43], v10 offset:31232
    ds_read_b64_tr_b16 v[44:45], v11 offset:30720
    ds_read_b64_tr_b16 v[46:47], v11 offset:31232
    v_dot2_f32_bf16 v0, v252, v124, v0
    v_dot2_f32_bf16 v0, v253, v125, v0
    v_dot2_f32_bf16 v0, v254, v126, v0
    v_dot2_f32_bf16 v0, v255, v127, v0
    v_mfma_f32_32x32x16_bf16 v[80:95], v[64:67], v[248:251], v[80:95]
    v_and_b32 v2, 0x33, v1
    v_bfe_u32 v3, v1, 2, 1
    v_lshl_or_b32 v2, v3, 3, v2
    v_bfe_u32 v3, v1, 3, 1
    v_lshl_or_b32 v2, v3, 2, v2
    v_mfma_f32_32x32x16_bf16 v[96:111], v[68:71], v[248:251], v[96:111]
    v_lshlrev_b32 v2, 4, v2
    v_mov_b32 v6, s69
    v_cmp_gt_u32 vcc, 4, v6
    v_and_b32 v3, 15, v1
    v_mfma_f32_32x32x16_bf16 v[80:95], v[72:75], v[252:255], v[80:95]
    v_lshlrev_b32 v3, 4, v3
    v_cndmask_b32 v4, v14, v2, vcc
    v_cndmask_b32 v5, v2, v14, vcc
    v_lshrrev_b32 v2, 5, v1
    v_mfma_f32_32x32x16_bf16 v[96:111], v[76:79], v[252:255], v[96:111]
    v_lshl_add_u32 v3, v2, 8, v3
    v_bfe_u32 v2, v1, 4, 1
    v_lshl_add_u32 v3, v2, 17, v3
    v_add_u32 v3, 1024, v3
    s_nop 6
    s_cmp_lt_u32 s69, 4
    s_cbranch_scc1 L_noscale0
    v_mul_f32 v80, s32, v80
    v_mul_f32 v81, s32, v81
    v_mul_f32 v82, s32, v82
    v_mul_f32 v83, s32, v83
    v_mul_f32 v84, s32, v84
    v_mul_f32 v85, s32, v85
    v_mul_f32 v86, s32, v86
    v_mul_f32 v87, s32, v87
    v_mul_f32 v88, s32, v88
    v_mul_f32 v89, s32, v89
    v_mul_f32 v90, s32, v90
    v_mul_f32 v91, s32, v91
    v_mul_f32 v92, s32, v92
    v_mul_f32 v93, s32, v93
    v_mul_f32 v94, s32, v94
    v_mul_f32 v95, s32, v95
    v_mul_f32 v96, s32, v96
    v_mul_f32 v97, s32, v97
    v_mul_f32 v98, s32, v98
    v_mul_f32 v99, s32, v99
    v_mul_f32 v100, s32, v100
    v_mul_f32 v101, s32, v101
    v_mul_f32 v102, s32, v102
    v_mul_f32 v103, s32, v103
    v_mul_f32 v104, s32, v104
    v_mul_f32 v105, s32, v105
    v_mul_f32 v106, s32, v106
    v_mul_f32 v107, s32, v107
    v_mul_f32 v108, s32, v108
    v_mul_f32 v109, s32, v109
    v_mul_f32 v110, s32, v110
    v_mul_f32 v111, s32, v111
L_noscale0:
    v_cvt_pk_bf16_f32 v48, v80, v81
    v_cvt_pk_bf16_f32 v49, v82, v83
    v_cvt_pk_bf16_f32 v50, v84, v85
    v_cvt_pk_bf16_f32 v51, v86, v87
    buffer_store_dwordx4 v[48:51], v4, s[36:39], s24 offen sc1
    s_add_u32 s24, s24, s25
    v_cvt_pk_bf16_f32 v52, v88, v89
    v_cvt_pk_bf16_f32 v53, v90, v91
    v_cvt_pk_bf16_f32 v54, v92, v93
    v_cvt_pk_bf16_f32 v55, v94, v95
    buffer_store_dwordx4 v[52:55], v4, s[36:39], s24 offen sc1
    s_add_u32 s24, s24, s25
    v_cvt_pk_bf16_f32 v56, v96, v97
    v_cvt_pk_bf16_f32 v57, v98, v99
    v_cvt_pk_bf16_f32 v58, v100, v101
    v_cvt_pk_bf16_f32 v59, v102, v103
    buffer_store_dwordx4 v[56:59], v4, s[36:39], s24 offen sc1
    s_add_u32 s24, s24, s25
    v_cvt_pk_bf16_f32 v60, v104, v105
    v_cvt_pk_bf16_f32 v61, v106, v107
    v_cvt_pk_bf16_f32 v62, v108, v109
    v_cvt_pk_bf16_f32 v63, v110, v111
    buffer_store_dwordx4 v[60:63], v4, s[36:39], s24 offen sc1
    s_add_u32 s24, s24, s25
    s_nop 1
    v_and_b32 v115, 15, v1
    v_mul_u32_u24 v115, 16, v115
    s_cmp_lg_u32 s56, 0
    s_cbranch_scc1 L_noipq
    buffer_load_dword v114, v115, s[48:51], 0 offen sc1
L_noipq:
    s_mov_b32 s34, 0
    s_waitcnt lgkmcnt(0)
    v_mfma_f32_32x32x16_bf16 v[80:95], v[128:131], v[16:19], 0
    ds_read_b64_tr_b16 v[48:49], v12 offset:57344
    ds_read_b64_tr_b16 v[50:51], v12 offset:57856
    ds_read_b64_tr_b16 v[52:53], v13 offset:57344
    ds_read_b64_tr_b16 v[54:55], v13 offset:57856
    v_mov_b32 v113, v0
    v_and_b32 v119, 31, v1
    v_mfma_f32_32x32x16_bf16 v[96:111], v[128:131], v[20:23], 0
    ds_read_b64_tr_b16 v[56:57], v12 offset:59392
    ds_read_b64_tr_b16 v[58:59], v12 offset:59904
    ds_read_b64_tr_b16 v[60:61], v13 offset:59392
    ds_read_b64_tr_b16 v[62:63], v13 offset:59904
    s_lshl_b32 s62, s56, 7
    v_permlane32_swap_b32 v0, v113
    v_mfma_f32_32x32x16_bf16 v[80:95], v[132:135], v[24:27], v[80:95]
    ds_read_b64_tr_b16 v[64:65], v12 offset:61440
    ds_read_b64_tr_b16 v[66:67], v12 offset:61952
    ds_read_b64_tr_b16 v[68:69], v13 offset:61440
    ds_read_b64_tr_b16 v[70:71], v13 offset:61952
    v_add_f32 v113, v0, v113
    v_mul_f32 v113, 0xbfb8aa3b, v113
    v_mfma_f32_32x32x16_bf16 v[96:111], v[132:135], v[28:31], v[96:111]
    ds_read_b64_tr_b16 v[72:73], v12 offset:63488
    ds_read_b64_tr_b16 v[74:75], v12 offset:64000
    ds_read_b64_tr_b16 v[76:77], v13 offset:63488
    ds_read_b64_tr_b16 v[78:79], v13 offset:64000
    v_exp_f32 v113, v113
    s_add_u32 s62, s62, 29696
    v_mfma_f32_32x32x16_bf16 v[80:95], v[136:139], v[32:35], v[80:95]
    v_add_f32 v113, 1.0, v113
    v_rcp_f32 v113, v113
    v_mfma_f32_32x32x16_bf16 v[96:111], v[136:139], v[36:39], v[96:111]
    v_lshl_add_u32 v119, v119, 2, s62
    ds_write_b32 v119, v113
    v_mfma_f32_32x32x16_bf16 v[80:95], v[140:143], v[40:43], v[80:95]
    v_mfma_f32_32x32x16_bf16 v[96:111], v[140:143], v[44:47], v[96:111]
    s_waitcnt lgkmcnt(0)
    v_mfma_f32_32x32x16_bf16 v[80:95], v[144:147], v[48:51], v[80:95]
    s_barrier
    ds_read_b64_tr_b16 v[16:17], v10 offset:0
    ds_read_b64_tr_b16 v[18:19], v10 offset:512
    ds_read_b64_tr_b16 v[20:21], v11 offset:0
    ds_read_b64_tr_b16 v[22:23], v11 offset:512
    s_lshl_b32 s20, s57, 17
    s_and_b32 s4, s56, 1
    v_mfma_f32_32x32x16_bf16 v[96:111], v[144:147], v[52:55], v[96:111]
    ds_read_b64_tr_b16 v[24:25], v10 offset:2048
    ds_read_b64_tr_b16 v[26:27], v10 offset:2560
    ds_read_b64_tr_b16 v[28:29], v11 offset:2048
    ds_read_b64_tr_b16 v[30:31], v11 offset:2560
    s_lshl_b32 s4, s4, 16
    v_mfma_f32_32x32x16_bf16 v[80:95], v[148:151], v[56:59], v[80:95]
    ds_read_b64_tr_b16 v[32:33], v10 offset:4096
    ds_read_b64_tr_b16 v[34:35], v10 offset:4608
    ds_read_b64_tr_b16 v[36:37], v11 offset:4096
    ds_read_b64_tr_b16 v[38:39], v11 offset:4608
    s_add_u32 s20, s20, s4
    v_mfma_f32_32x32x16_bf16 v[96:111], v[148:151], v[60:63], v[96:111]
    ds_read_b64_tr_b16 v[40:41], v10 offset:6144
    ds_read_b64_tr_b16 v[42:43], v10 offset:6656
    ds_read_b64_tr_b16 v[44:45], v11 offset:6144
    ds_read_b64_tr_b16 v[46:47], v11 offset:6656
    s_lshr_b32 s4, s56, 1
    v_mfma_f32_32x32x16_bf16 v[80:95], v[152:155], v[64:67], v[80:95]
    s_lshl_b32 s4, s4, 13
    v_mfma_f32_32x32x16_bf16 v[96:111], v[152:155], v[68:71], v[96:111]
    s_add_u32 s20, s20, s4
    v_mfma_f32_32x32x16_bf16 v[80:95], v[156:159], v[72:75], v[80:95]
    s_add_u32 s20, s20, 0xc00000
    v_mfma_f32_32x32x16_bf16 v[96:111], v[156:159], v[76:79], v[96:111]
    v_lshrrev_b32 v116, 5, v1
    s_waitcnt lgkmcnt(0)
    v_mfma_f32_32x32x16_bf16 v[80:95], v[160:163], v[16:19], v[80:95]
    ds_read_b64_tr_b16 v[48:49], v10 offset:8192
    ds_read_b64_tr_b16 v[50:51], v10 offset:8704
    ds_read_b64_tr_b16 v[52:53], v11 offset:8192
    ds_read_b64_tr_b16 v[54:55], v11 offset:8704
    v_bfe_u32 v117, v1, 2, 2
    v_mfma_f32_32x32x16_bf16 v[96:111], v[160:163], v[20:23], v[96:111]
    ds_read_b64_tr_b16 v[56:57], v10 offset:10240
    ds_read_b64_tr_b16 v[58:59], v10 offset:10752
    ds_read_b64_tr_b16 v[60:61], v11 offset:10240
    ds_read_b64_tr_b16 v[62:63], v11 offset:10752
    v_lshl_add_u32 v8, v116, 2, v117
    v_mfma_f32_32x32x16_bf16 v[80:95], v[164:167], v[24:27], v[80:95]
    ds_read_b64_tr_b16 v[64:65], v10 offset:12288
    ds_read_b64_tr_b16 v[66:67], v10 offset:12800
    ds_read_b64_tr_b16 v[68:69], v11 offset:12288
    ds_read_b64_tr_b16 v[70:71], v11 offset:12800
    v_lshlrev_b32 v8, 7, v8
    v_mfma_f32_32x32x16_bf16 v[96:111], v[164:167], v[28:31], v[96:111]
    ds_read_b64_tr_b16 v[72:73], v10 offset:14336
    ds_read_b64_tr_b16 v[74:75], v10 offset:14848
    ds_read_b64_tr_b16 v[76:77], v11 offset:14336
    ds_read_b64_tr_b16 v[78:79], v11 offset:14848
    v_bfe_u32 v116, v1, 4, 1
    v_mfma_f32_32x32x16_bf16 v[80:95], v[168:171], v[32:35], v[80:95]
    v_lshlrev_b32 v116, 1, v116
    v_mfma_f32_32x32x16_bf16 v[96:111], v[168:171], v[36:39], v[96:111]
    v_bfe_u32 v117, v1, 1, 1
    v_mfma_f32_32x32x16_bf16 v[80:95], v[172:175], v[40:43], v[80:95]
    v_add_u32 v116, v116, v117
    v_mfma_f32_32x32x16_bf16 v[96:111], v[172:175], v[44:47], v[96:111]
    v_bfe_u32 v117, v1, 3, 1
    s_waitcnt lgkmcnt(0)
    v_mfma_f32_32x32x16_bf16 v[80:95], v[176:179], v[48:51], v[80:95]
    s_barrier
    s_and_b32 s62, s69, 1
    s_lshl_b32 s62, s62, 1
    s_and_b32 s63, s56, 1
    s_add_u32 s62, s62, s63
    s_lshl_b32 s62, s62, 7
    s_add_u32 s62, s62, 29696
    v_and_b32 v118, 31, v1
    v_lshl_add_u32 v118, v118, 2, s62
    ds_read_b32 v112, v118
    ds_read_b64_tr_b16 v[16:17], v10 offset:16384
    ds_read_b64_tr_b16 v[18:19], v10 offset:16896
    ds_read_b64_tr_b16 v[20:21], v11 offset:16384
    ds_read_b64_tr_b16 v[22:23], v11 offset:16896
    v_lshl_or_b32 v116, v117, 2, v116
    v_lshl_add_u32 v8, v116, 4, v8
    v_mfma_f32_32x32x16_bf16 v[96:111], v[176:179], v[52:55], v[96:111]
    ds_read_b64_tr_b16 v[24:25], v10 offset:18432
    ds_read_b64_tr_b16 v[26:27], v10 offset:18944
    ds_read_b64_tr_b16 v[28:29], v11 offset:18432
    ds_read_b64_tr_b16 v[30:31], v11 offset:18944
    v_and_b32 v116, 1, v1
    v_mfma_f32_32x32x16_bf16 v[80:95], v[180:183], v[56:59], v[80:95]
    ds_read_b64_tr_b16 v[32:33], v10 offset:20480
    ds_read_b64_tr_b16 v[34:35], v10 offset:20992
    ds_read_b64_tr_b16 v[36:37], v11 offset:20480
    ds_read_b64_tr_b16 v[38:39], v11 offset:20992
    v_lshl_add_u32 v8, v116, 3, v8
    v_mfma_f32_32x32x16_bf16 v[96:111], v[180:183], v[60:63], v[96:111]
    ds_read_b64_tr_b16 v[40:41], v10 offset:22528
    ds_read_b64_tr_b16 v[42:43], v10 offset:23040
    ds_read_b64_tr_b16 v[44:45], v11 offset:22528
    ds_read_b64_tr_b16 v[46:47], v11 offset:23040
    s_lshr_b32 s4, s56, 1
    v_mfma_f32_32x32x16_bf16 v[80:95], v[184:187], v[64:67], v[80:95]
    s_lshl_b32 s4, s4, 14
    v_mfma_f32_32x32x16_bf16 v[96:111], v[184:187], v[68:71], v[96:111]
    s_add_u32 s4, s4, 65536
    v_mfma_f32_32x32x16_bf16 v[80:95], v[188:191], v[72:75], v[80:95]
    v_add_u32 v8, s4, v8
    v_mfma_f32_32x32x16_bf16 v[96:111], v[188:191], v[76:79], v[96:111]
    v_xor_b32 v9, 64, v8
    s_waitcnt lgkmcnt(0)
    v_mfma_f32_32x32x16_bf16 v[80:95], v[192:195], v[16:19], v[80:95]
    ds_read_b64_tr_b16 v[48:49], v10 offset:32768
    ds_read_b64_tr_b16 v[50:51], v10 offset:33280
    ds_read_b64_tr_b16 v[52:53], v11 offset:32768
    ds_read_b64_tr_b16 v[54:55], v11 offset:33280
    s_lshr_b32 s4, s56, 1
    v_mfma_f32_32x32x16_bf16 v[96:111], v[192:195], v[20:23], v[96:111]
    ds_read_b64_tr_b16 v[56:57], v10 offset:34816
    ds_read_b64_tr_b16 v[58:59], v10 offset:35328
    ds_read_b64_tr_b16 v[60:61], v11 offset:34816
    ds_read_b64_tr_b16 v[62:63], v11 offset:35328
    s_mul_i32 s4, s4, 17408
    v_mfma_f32_32x32x16_bf16 v[80:95], v[196:199], v[24:27], v[80:95]
    ds_read_b64_tr_b16 v[64:65], v10 offset:36864
    ds_read_b64_tr_b16 v[66:67], v10 offset:37376
    ds_read_b64_tr_b16 v[68:69], v11 offset:36864
    ds_read_b64_tr_b16 v[70:71], v11 offset:37376
    s_and_b32 s5, s56, 1
    v_mfma_f32_32x32x16_bf16 v[96:111], v[196:199], v[28:31], v[96:111]
    ds_read_b64_tr_b16 v[72:73], v10 offset:38912
    ds_read_b64_tr_b16 v[74:75], v10 offset:39424
    ds_read_b64_tr_b16 v[76:77], v11 offset:38912
    ds_read_b64_tr_b16 v[78:79], v11 offset:39424
    s_mul_i32 s5, s5, 8704
    v_mfma_f32_32x32x16_bf16 v[80:95], v[200:203], v[32:35], v[80:95]
    s_add_u32 s4, s4, s5
    v_mfma_f32_32x32x16_bf16 v[96:111], v[200:203], v[36:39], v[96:111]
    s_add_u32 s4, s4, 65536
    v_mfma_f32_32x32x16_bf16 v[80:95], v[204:207], v[40:43], v[80:95]
    v_add_u32 v2, s4, v14
    v_mfma_f32_32x32x16_bf16 v[96:111], v[204:207], v[44:47], v[96:111]
    v_and_b32 v116, 7, v1
    s_waitcnt lgkmcnt(0)
    v_mfma_f32_32x32x16_bf16 v[80:95], v[208:211], v[48:51], v[80:95]
    s_waitcnt vmcnt(0)
    s_cmp_lg_u32 s56, 0
    s_cbranch_scc1 L_noinitchkq
    s_mov_b32 s65, 131072
    s_branch L_chk3
L_spin3:
    buffer_load_dword v114, v115, s[48:51], 0 offen sc1
L_chk3:
    s_waitcnt vmcnt(0)
    v_cmp_eq_u32 vcc, 1, v114
    s_sub_u32 s65, s65, 1
    s_cbranch_scc1 L_ok3
    s_cmp_eq_u64 vcc, -1
    s_cbranch_scc0 L_spin3
L_ok3:
L_noinitchkq:
    s_barrier
    s_cmp_lg_u32 s56, 0
    s_cbranch_scc1 L_nopub1q
    v_mov_b32 v114, 1
    s_lshl_b32 s62, s2, 7
    s_add_u32 s62, s62, 0x1000000
    s_mov_b64 exec, 1
    buffer_store_dword v114, v14, s[36:39], s62 offen sc1
    s_mov_b64 exec, -1
L_nopub1q:
    ds_read_b64_tr_b16 v[16:17], v10 offset:40960
    ds_read_b64_tr_b16 v[18:19], v10 offset:41472
    ds_read_b64_tr_b16 v[20:21], v11 offset:40960
    ds_read_b64_tr_b16 v[22:23], v11 offset:41472
    v_lshrrev_b32 v117, 3, v1
    s_and_b32 s4, s56, 3
    v_mfma_f32_32x32x16_bf16 v[96:111], v[208:211], v[52:55], v[96:111]
    ds_read_b64_tr_b16 v[24:25], v10 offset:43008
    ds_read_b64_tr_b16 v[26:27], v10 offset:43520
    ds_read_b64_tr_b16 v[28:29], v11 offset:43008
    ds_read_b64_tr_b16 v[30:31], v11 offset:43520
    s_lshl_b32 s4, s4, 3
    v_mfma_f32_32x32x16_bf16 v[80:95], v[212:215], v[56:59], v[80:95]
    ds_read_b64_tr_b16 v[32:33], v10 offset:45056
    ds_read_b64_tr_b16 v[34:35], v10 offset:45568
    ds_read_b64_tr_b16 v[36:37], v11 offset:45056
    ds_read_b64_tr_b16 v[38:39], v11 offset:45568
    v_add_u32 v117, s4, v117
    v_mfma_f32_32x32x16_bf16 v[96:111], v[212:215], v[60:63], v[96:111]
    ds_read_b64_tr_b16 v[40:41], v10 offset:47104
    ds_read_b64_tr_b16 v[42:43], v10 offset:47616
    ds_read_b64_tr_b16 v[44:45], v11 offset:47104
    ds_read_b64_tr_b16 v[46:47], v11 offset:47616
    v_mul_u32_u24 v7, 1088, v116
    v_mfma_f32_32x32x16_bf16 v[80:95], v[216:219], v[64:67], v[80:95]
    v_lshl_add_u32 v7, v117, 4, v7
    v_mfma_f32_32x32x16_bf16 v[96:111], v[216:219], v[68:71], v[96:111]
    s_lshr_b32 s4, s56, 2
    v_mfma_f32_32x32x16_bf16 v[80:95], v[220:223], v[72:75], v[80:95]
    s_mul_i32 s5, s4, 8704
    v_mfma_f32_32x32x16_bf16 v[96:111], v[220:223], v[76:79], v[96:111]
    s_add_u32 s5, s5, 65536
    s_waitcnt lgkmcnt(0)
    v_mfma_f32_32x32x16_bf16 v[80:95], v[224:227], v[16:19], v[80:95]
    ds_read_b64_tr_b16 v[48:49], v10 offset:49152
    ds_read_b64_tr_b16 v[50:51], v10 offset:49664
    ds_read_b64_tr_b16 v[52:53], v11 offset:49152
    ds_read_b64_tr_b16 v[54:55], v11 offset:49664
    v_add_u32 v7, s5, v7
    v_mfma_f32_32x32x16_bf16 v[96:111], v[224:227], v[20:23], v[96:111]
    ds_read_b64_tr_b16 v[56:57], v10 offset:51200
    ds_read_b64_tr_b16 v[58:59], v10 offset:51712
    ds_read_b64_tr_b16 v[60:61], v11 offset:51200
    ds_read_b64_tr_b16 v[62:63], v11 offset:51712
    v_lshlrev_b32 v6, 10, v117
    v_mfma_f32_32x32x16_bf16 v[80:95], v[228:231], v[24:27], v[80:95]
    ds_read_b64_tr_b16 v[64:65], v10 offset:53248
    ds_read_b64_tr_b16 v[66:67], v10 offset:53760
    ds_read_b64_tr_b16 v[68:69], v11 offset:53248
    ds_read_b64_tr_b16 v[70:71], v11 offset:53760
    v_lshl_add_u32 v6, v116, 4, v6
    v_mfma_f32_32x32x16_bf16 v[96:111], v[228:231], v[28:31], v[96:111]
    ds_read_b64_tr_b16 v[72:73], v10 offset:55296
    ds_read_b64_tr_b16 v[74:75], v10 offset:55808
    ds_read_b64_tr_b16 v[76:77], v11 offset:55296
    ds_read_b64_tr_b16 v[78:79], v11 offset:55808
    s_lshl_b32 s4, s4, 15
    v_mfma_f32_32x32x16_bf16 v[80:95], v[232:235], v[32:35], v[80:95]
    s_lshl_b32 s5, s57, 16
    v_mfma_f32_32x32x16_bf16 v[96:111], v[232:235], v[36:39], v[96:111]
    s_add_u32 s4, s4, s5
    v_mfma_f32_32x32x16_bf16 v[80:95], v[236:239], v[40:43], v[80:95]
    s_lshl_b32 s5, s58, 7
    v_mfma_f32_32x32x16_bf16 v[96:111], v[236:239], v[44:47], v[96:111]
    s_add_u32 s33, s4, s5
    s_waitcnt lgkmcnt(0)
    v_mfma_f32_32x32x16_bf16 v[80:95], v[240:243], v[48:51], v[80:95]
    ds_read_b64_tr_b16 v[16:17], v10 offset:57344
    ds_read_b64_tr_b16 v[18:19], v10 offset:57856
    ds_read_b64_tr_b16 v[20:21], v11 offset:57344
    ds_read_b64_tr_b16 v[22:23], v11 offset:57856
    v_mfma_f32_32x32x16_bf16 v[96:111], v[240:243], v[52:55], v[96:111]
    ds_read_b64_tr_b16 v[24:25], v10 offset:59392
    ds_read_b64_tr_b16 v[26:27], v10 offset:59904
    ds_read_b64_tr_b16 v[28:29], v11 offset:59392
    ds_read_b64_tr_b16 v[30:31], v11 offset:59904
    v_mfma_f32_32x32x16_bf16 v[80:95], v[244:247], v[56:59], v[80:95]
    ds_read_b64_tr_b16 v[32:33], v10 offset:61440
    ds_read_b64_tr_b16 v[34:35], v10 offset:61952
    ds_read_b64_tr_b16 v[36:37], v11 offset:61440
    ds_read_b64_tr_b16 v[38:39], v11 offset:61952
    v_mfma_f32_32x32x16_bf16 v[96:111], v[244:247], v[60:63], v[96:111]
    ds_read_b64_tr_b16 v[40:41], v10 offset:63488
    ds_read_b64_tr_b16 v[42:43], v10 offset:64000
    ds_read_b64_tr_b16 v[44:45], v11 offset:63488
    ds_read_b64_tr_b16 v[46:47], v11 offset:64000
    v_mfma_f32_32x32x16_bf16 v[80:95], v[248:251], v[64:67], v[80:95]
    v_mfma_f32_32x32x16_bf16 v[96:111], v[248:251], v[68:71], v[96:111]
    v_mfma_f32_32x32x16_bf16 v[80:95], v[252:255], v[72:75], v[80:95]
    v_mfma_f32_32x32x16_bf16 v[96:111], v[252:255], v[76:79], v[96:111]
    s_nop 10
    v_cvt_pk_bf16_f32 v48, v80, v81
    v_cvt_pk_bf16_f32 v49, v82, v83
    v_cvt_pk_bf16_f32 v50, v84, v85
    v_cvt_pk_bf16_f32 v51, v86, v87
    buffer_store_dwordx4 v[48:51], v3, s[36:39], s28 offen offset:0 sc1
    v_cvt_pk_bf16_f32 v52, v88, v89
    v_cvt_pk_bf16_f32 v53, v90, v91
    v_cvt_pk_bf16_f32 v54, v92, v93
    v_cvt_pk_bf16_f32 v55, v94, v95
    buffer_store_dwordx4 v[52:55], v3, s[36:39], s28 offen offset:512 sc1
    v_cvt_pk_bf16_f32 v56, v96, v97
    v_cvt_pk_bf16_f32 v57, v98, v99
    v_cvt_pk_bf16_f32 v58, v100, v101
    v_cvt_pk_bf16_f32 v59, v102, v103
    buffer_store_dwordx4 v[56:59], v3, s[36:39], s29 offen offset:0 sc1
    v_cvt_pk_bf16_f32 v60, v104, v105
    v_cvt_pk_bf16_f32 v61, v106, v107
    v_cvt_pk_bf16_f32 v62, v108, v109
    v_cvt_pk_bf16_f32 v63, v110, v111
    buffer_store_dwordx4 v[60:63], v3, s[36:39], s29 offen offset:512 sc1
    s_nop 1
L_p3:
    s_waitcnt lgkmcnt(0)
    v_mfma_f32_32x32x16_bf16 v[80:95], v[16:19], v[128:131], 0
    ds_read_b64_tr_b16 v[48:49], v12 offset:24576
    ds_read_b64_tr_b16 v[50:51], v12 offset:25088
    ds_read_b64_tr_b16 v[52:53], v13 offset:24576
    ds_read_b64_tr_b16 v[54:55], v13 offset:25088
    s_lshl_b32 s11, s59, 6
    s_add_u32 s11, s11, s61
    s_lshl_b32 s11, s11, 10
    v_mfma_f32_32x32x16_bf16 v[96:111], v[20:23], v[128:131], 0
    ds_read_b64_tr_b16 v[56:57], v12 offset:26624
    ds_read_b64_tr_b16 v[58:59], v12 offset:27136
    ds_read_b64_tr_b16 v[60:61], v13 offset:26624
    ds_read_b64_tr_b16 v[62:63], v13 offset:27136
    s_add_u32 s11, s11, 0x800000
    s_lshl_b32 s13, s59, 17
    s_add_u32 s14, s13, 0x400000
    v_mfma_f32_32x32x16_bf16 v[80:95], v[24:27], v[132:135], v[80:95]
    ds_read_b64_tr_b16 v[64:65], v12 offset:28672
    ds_read_b64_tr_b16 v[66:67], v12 offset:29184
    ds_read_b64_tr_b16 v[68:69], v13 offset:28672
    ds_read_b64_tr_b16 v[70:71], v13 offset:29184
    s_mov_b32 s10, 0x1000000
    s_and_b32 s4, s2, 3
    s_add_u32 s5, s4, 3
    v_mfma_f32_32x32x16_bf16 v[96:111], v[28:31], v[132:135], v[96:111]
    ds_read_b64_tr_b16 v[72:73], v12 offset:30720
    ds_read_b64_tr_b16 v[74:75], v12 offset:31232
    ds_read_b64_tr_b16 v[76:77], v13 offset:30720
    ds_read_b64_tr_b16 v[78:79], v13 offset:31232
    s_and_b32 s5, s5, 3
    s_xor_b32 s6, s4, 2
    s_and_b32 s7, s2, 1
    v_mfma_f32_32x32x16_bf16 v[80:95], v[32:35], v[136:139], v[80:95]
    s_mul_i32 s7, s7, 0x1011
    s_lshl_b32 s9, s4, 8
    s_add_u32 s7, s7, s9
    v_mfma_f32_32x32x16_bf16 v[96:111], v[36:39], v[136:139], v[96:111]
    s_add_u32 s7, s7, 0x420
    s_mul_i32 s6, s6, 0x110
    s_add_u32 s5, s5, s6
    v_mfma_f32_32x32x16_bf16 v[80:95], v[40:43], v[140:143], v[80:95]
    s_add_u32 s5, s5, 0x404
    v_mfma_f32_32x32x16_bf16 v[96:111], v[44:47], v[140:143], v[96:111]
    s_waitcnt lgkmcnt(0)
    v_mfma_f32_32x32x16_bf16 v[80:95], v[48:51], v[144:147], v[80:95]
    s_barrier
    ds_read_b64_tr_b16 v[16:17], v12 offset:0
    ds_read_b64_tr_b16 v[18:19], v12 offset:512
    ds_read_b64_tr_b16 v[20:21], v13 offset:0
    ds_read_b64_tr_b16 v[22:23], v13 offset:512
    v_bfe_u32 v133, v1, 2, 2
    v_and_b32 v136, 3, v1
    v_lshl_add_u32 v133, v136, 3, v133
    v_mfma_f32_32x32x16_bf16 v[96:111], v[52:55], v[144:147], v[96:111]
    ds_read_b64_tr_b16 v[24:25], v12 offset:2048
    ds_read_b64_tr_b16 v[26:27], v12 offset:2560
    ds_read_b64_tr_b16 v[28:29], v13 offset:2048
    ds_read_b64_tr_b16 v[30:31], v13 offset:2560
    v_lshlrev_b32 v133, 7, v133
    v_lshrrev_b32 v136, 4, v1
    v_lshlrev_b32 v136, 2, v136
    v_mfma_f32_32x32x16_bf16 v[80:95], v[56:59], v[148:151], v[80:95]
    ds_read_b64_tr_b16 v[32:33], v12 offset:4096
    ds_read_b64_tr_b16 v[34:35], v12 offset:4608
    ds_read_b64_tr_b16 v[36:37], v13 offset:4096
    ds_read_b64_tr_b16 v[38:39], v13 offset:4608
    v_bfe_u32 v138, s7, v136, 4
    v_lshl_add_u32 v138, v138, 12, v133
    v_bfe_u32 v140, s5, v136, 4
    v_mfma_f32_32x32x16_bf16 v[96:111], v[60:63], v[148:151], v[96:111]
    ds_read_b64_tr_b16 v[40:41], v12 offset:6144
    ds_read_b64_tr_b16 v[42:43], v12 offset:6656
    ds_read_b64_tr_b16 v[44:45], v13 offset:6144
    ds_read_b64_tr_b16 v[46:47], v13 offset:6656
    v_lshl_add_u32 v140, v140, 12, v133
    s_and_b32 s4, s2, 4
    s_lshl_b32 s4, s4, 7
    v_mfma_f32_32x32x16_bf16 v[80:95], v[64:67], v[152:155], v[80:95]
    v_add_u32 v138, s4, v138
    v_add_u32 v140, s4, v140
    v_and_b32 v133, 0xc80, v133
    v_mfma_f32_32x32x16_bf16 v[96:111], v[68:71], v[152:155], v[96:111]
    s_lshr_b32 s4, s56, 1
    s_lshl_b32 s4, s4, 8
    s_lshr_b32 s5, s57, 2
    v_mfma_f32_32x32x16_bf16 v[80:95], v[72:75], v[156:159], v[80:95]
    s_lshl_b32 s5, s5, 12
    s_add_u32 s4, s4, s5
    v_add_u32 v133, s4, v133
    v_mfma_f32_32x32x16_bf16 v[96:111], v[76:79], v[156:159], v[96:111]
    v_cmp_lt_u32 vcc, 47, v1
    s_bfe_u32 s4, s2, 0x10001
    s_lshl_b32 s4, s4, 15
    s_waitcnt lgkmcnt(0)
    v_mfma_f32_32x32x16_bf16 v[80:95], v[16:19], v[160:163], v[80:95]
    ds_read_b64_tr_b16 v[48:49], v12 offset:8192
    ds_read_b64_tr_b16 v[50:51], v12 offset:8704
    ds_read_b64_tr_b16 v[52:53], v13 offset:8192
    ds_read_b64_tr_b16 v[54:55], v13 offset:8704
    v_cndmask_b32 v140, v140, v133, vcc
    s_add_u32 s16, s14, s4
    s_xor_b32 s4, s4, 0x8000
    v_mfma_f32_32x32x16_bf16 v[96:111], v[20:23], v[160:163], v[96:111]
    ds_read_b64_tr_b16 v[56:57], v12 offset:10240
    ds_read_b64_tr_b16 v[58:59], v12 offset:10752
    ds_read_b64_tr_b16 v[60:61], v13 offset:10240
    ds_read_b64_tr_b16 v[62:63], v13 offset:10752
    s_add_u32 s21, s14, s4
    v_lshrrev_b32 v133, 3, v1
    v_bfe_u32 v136, v1, 4, 1
    v_mfma_f32_32x32x16_bf16 v[80:95], v[24:27], v[164:167], v[80:95]
    ds_read_b64_tr_b16 v[64:65], v12 offset:12288
    ds_read_b64_tr_b16 v[66:67], v12 offset:12800
    ds_read_b64_tr_b16 v[68:69], v13 offset:12288
    ds_read_b64_tr_b16 v[70:71], v13 offset:12800
    v_lshlrev_b32 v136, 2, v136
    v_and_b32 v139, 7, v1
    v_xor_b32 v139, v139, v136
    v_mfma_f32_32x32x16_bf16 v[96:111], v[28:31], v[164:167], v[96:111]
    ds_read_b64_tr_b16 v[72:73], v12 offset:14336
    ds_read_b64_tr_b16 v[74:75], v12 offset:14848
    ds_read_b64_tr_b16 v[76:77], v13 offset:14336
    ds_read_b64_tr_b16 v[78:79], v13 offset:14848
    v_lshlrev_b32 v139, 4, v139
    v_lshl_add_u32 v139, v133, 10, v139
    v_mov_b32 v128, 0xdddddddd
    v_mfma_f32_32x32x16_bf16 v[80:95], v[32:35], v[168:171], v[80:95]
    s_mov_b32 s22, 0x0000ffff
    s_mov_b32 s23, 0x0000ffff
    v_lshrrev_b32 v137, 5, v1
    v_mfma_f32_32x32x16_bf16 v[96:111], v[36:39], v[168:171], v[96:111]
    v_and_b32 v132, 15, v1
    v_lshlrev_b32 v132, 4, v132
    v_lshl_add_u32 v132, v137, 8, v132
    v_mfma_f32_32x32x16_bf16 v[80:95], v[40:43], v[172:175], v[80:95]
    v_add_u32 v132, 1024, v132
    s_lshl_b32 s4, s56, 11
    s_add_u32 s4, s4, 131072
    v_mfma_f32_32x32x16_bf16 v[96:111], v[44:47], v[172:175], v[96:111]
    v_add_u32 v129, s4, v14
    v_add_u32 v130, s4, v132
    s_lshl_b32 s4, s56, 10
    s_waitcnt lgkmcnt(0)
    v_mfma_f32_32x32x16_bf16 v[80:95], v[48:51], v[176:179], v[80:95]
    ds_read_b64_tr_b16 v[16:17], v12 offset:16384
    ds_read_b64_tr_b16 v[18:19], v12 offset:16896
    ds_read_b64_tr_b16 v[20:21], v13 offset:16384
    ds_read_b64_tr_b16 v[22:23], v13 offset:16896
    s_add_u32 s4, s4, 155648
    v_add_u32 v131, s4, v14
    v_and_b32 v134, 31, v1
    v_mfma_f32_32x32x16_bf16 v[96:111], v[52:55], v[176:179], v[96:111]
    ds_read_b64_tr_b16 v[24:25], v12 offset:18432
    ds_read_b64_tr_b16 v[26:27], v12 offset:18944
    ds_read_b64_tr_b16 v[28:29], v13 offset:18432
    ds_read_b64_tr_b16 v[30:31], v13 offset:18944
    v_lshlrev_b32 v137, 3, v137
    v_sub_u32 v137, v134, v137
    v_and_b32 v133, 0x1b, v134
    v_mfma_f32_32x32x16_bf16 v[80:95], v[56:59], v[180:183], v[80:95]
    ds_read_b64_tr_b16 v[32:33], v12 offset:20480
    ds_read_b64_tr_b16 v[34:35], v12 offset:20992
    ds_read_b64_tr_b16 v[36:37], v13 offset:20480
    ds_read_b64_tr_b16 v[38:39], v13 offset:20992
    v_cmp_eq_u32 vcc, 16, v133
    v_mov_b32 v136, 0x3f803f80
    v_mov_b32 v133, 0
    v_mfma_f32_32x32x16_bf16 v[96:111], v[60:63], v[180:183], v[96:111]
    ds_read_b64_tr_b16 v[40:41], v12 offset:22528
    ds_read_b64_tr_b16 v[42:43], v12 offset:23040
    ds_read_b64_tr_b16 v[44:45], v13 offset:22528
    ds_read_b64_tr_b16 v[46:47], v13 offset:23040
    v_cndmask_b32 v144, v133, v136, vcc
    v_cndmask_b32 v145, v133, v136, vcc
    v_cndmask_b32 v146, v133, v136, vcc
    v_mfma_f32_32x32x16_bf16 v[80:95], v[64:67], v[184:187], v[80:95]
    v_cndmask_b32 v147, v133, v136, vcc
    v_cndmask_b32 v148, v133, v136, vcc
    v_cndmask_b32 v149, v133, v136, vcc
    v_mfma_f32_32x32x16_bf16 v[96:111], v[68:71], v[184:187], v[96:111]
    v_cndmask_b32 v150, v133, v136, vcc
    v_cndmask_b32 v151, v133, v136, vcc
    v_cndmask_b32 v152, v133, v136, vcc
    v_mfma_f32_32x32x16_bf16 v[80:95], v[72:75], v[188:191], v[80:95]
    v_cndmask_b32 v153, v133, v136, vcc
    v_cndmask_b32 v154, v133, v136, vcc
    v_cndmask_b32 v155, v133, v136, vcc
    v_mfma_f32_32x32x16_bf16 v[96:111], v[76:79], v[188:191], v[96:111]
    v_cndmask_b32 v156, v133, v136, vcc
    v_cndmask_b32 v157, v133, v136, vcc
    v_cndmask_b32 v158, v133, v136, vcc
    s_waitcnt lgkmcnt(0)
    v_mfma_f32_32x32x16_bf16 v[80:95], v[16:19], v[192:195], v[80:95]
    ds_read_b64_tr_b16 v[48:49], v12 offset:32768
    ds_read_b64_tr_b16 v[50:51], v12 offset:33280
    ds_read_b64_tr_b16 v[52:53], v13 offset:32768
    ds_read_b64_tr_b16 v[54:55], v13 offset:33280
    v_cndmask_b32 v159, v133, v136, vcc
    s_mov_b32 s5, 0xff800000
    s_cmp_eq_u32 s60, 0
    s_cselect_b32 s6, s5, 0
    s_cselect_b32 s7, s56, 64
    v_mfma_f32_32x32x16_bf16 v[96:111], v[20:23], v[192:195], v[96:111]
    ds_read_b64_tr_b16 v[56:57], v12 offset:34816
    ds_read_b64_tr_b16 v[58:59], v12 offset:35328
    ds_read_b64_tr_b16 v[60:61], v13 offset:34816
    ds_read_b64_tr_b16 v[62:63], v13 offset:35328
    v_mov_b32 v135, s5
    s_mov_b32 s8, 0
    s_lshl_b32 s15, s61, 6
    v_mfma_f32_32x32x16_bf16 v[80:95], v[24:27], v[196:199], v[80:95]
    ds_read_b64_tr_b16 v[64:65], v12 offset:36864
    ds_read_b64_tr_b16 v[66:67], v12 offset:37376
    ds_read_b64_tr_b16 v[68:69], v13 offset:36864
    ds_read_b64_tr_b16 v[70:71], v13 offset:37376
    s_add_u32 s15, s15, s59
    s_lshl_b32 s15, s15, 10
    s_add_u32 s15, s15, 0xc00000
    v_mfma_f32_32x32x16_bf16 v[96:111], v[28:31], v[196:199], v[96:111]
    ds_read_b64_tr_b16 v[72:73], v12 offset:38912
    ds_read_b64_tr_b16 v[74:75], v12 offset:39424
    ds_read_b64_tr_b16 v[76:77], v13 offset:38912
    ds_read_b64_tr_b16 v[78:79], v13 offset:39424
    v_mov_b32 v133, s5
    v_mov_b32 v136, s6
    v_cmp_le_i32 vcc, 0, v137
    v_mfma_f32_32x32x16_bf16 v[80:95], v[32:35], v[200:203], v[80:95]
    v_mov_b32 v160, 0
    s_nop 0
    v_cndmask_b32 v176, v133, v160, vcc
    v_mfma_f32_32x32x16_bf16 v[96:111], v[36:39], v[200:203], v[96:111]
    v_mfma_f32_32x32x16_bf16 v[80:95], v[40:43], v[204:207], v[80:95]
    v_mfma_f32_32x32x16_bf16 v[96:111], v[44:47], v[204:207], v[96:111]
    s_waitcnt lgkmcnt(0)
    v_mfma_f32_32x32x16_bf16 v[80:95], v[48:51], v[208:211], v[80:95]
    ds_read_b64_tr_b16 v[16:17], v12 offset:40960
    ds_read_b64_tr_b16 v[18:19], v12 offset:41472
    ds_read_b64_tr_b16 v[20:21], v13 offset:40960
    ds_read_b64_tr_b16 v[22:23], v13 offset:41472
    v_cndmask_b32 v192, v136, v133, vcc
    v_cmp_le_i32 vcc, 1, v137
    v_mov_b32 v161, 0
    s_nop 0
    v_mfma_f32_32x32x16_bf16 v[96:111], v[52:55], v[208:211], v[96:111]
    ds_read_b64_tr_b16 v[24:25], v12 offset:43008
    ds_read_b64_tr_b16 v[26:27], v12 offset:43520
    ds_read_b64_tr_b16 v[28:29], v13 offset:43008
    ds_read_b64_tr_b16 v[30:31], v13 offset:43520
    v_cndmask_b32 v177, v133, v161, vcc
    v_cndmask_b32 v193, v136, v133, vcc
    v_cmp_le_i32 vcc, 2, v137
    v_mov_b32 v162, 0
    v_mfma_f32_32x32x16_bf16 v[80:95], v[56:59], v[212:215], v[80:95]
    ds_read_b64_tr_b16 v[32:33], v12 offset:45056
    ds_read_b64_tr_b16 v[34:35], v12 offset:45568
    ds_read_b64_tr_b16 v[36:37], v13 offset:45056
    ds_read_b64_tr_b16 v[38:39], v13 offset:45568
    s_nop 0
    v_cndmask_b32 v178, v133, v162, vcc
    v_cndmask_b32 v194, v136, v133, vcc
    v_cmp_le_i32 vcc, 3, v137
    v_mfma_f32_32x32x16_bf16 v[96:111], v[60:63], v[212:215], v[96:111]
    ds_read_b64_tr_b16 v[40:41], v12 offset:47104
    ds_read_b64_tr_b16 v[42:43], v12 offset:47616
    ds_read_b64_tr_b16 v[44:45], v13 offset:47104
    ds_read_b64_tr_b16 v[46:47], v13 offset:47616
    v_mov_b32 v163, 0
    s_nop 0
    v_cndmask_b32 v179, v133, v163, vcc
    v_cndmask_b32 v195, v136, v133, vcc
    v_mfma_f32_32x32x16_bf16 v[80:95], v[64:67], v[216:219], v[80:95]
    v_cmp_le_i32 vcc, 4, v137
    v_mov_b32 v164, 0
    s_nop 0
    v_cndmask_b32 v180, v133, v164, vcc
    v_mfma_f32_32x32x16_bf16 v[96:111], v[68:71], v[216:219], v[96:111]
    v_cndmask_b32 v196, v136, v133, vcc
    v_cmp_le_i32 vcc, 5, v137
    v_mov_b32 v165, 0
    s_nop 0
    v_mfma_f32_32x32x16_bf16 v[80:95], v[72:75], v[220:223], v[80:95]
    v_cndmask_b32 v181, v133, v165, vcc
    v_cndmask_b32 v197, v136, v133, vcc
    v_cmp_le_i32 vcc, 6, v137
    v_mov_b32 v166, 0
    v_mfma_f32_32x32x16_bf16 v[96:111], v[76:79], v[220:223], v[96:111]
    s_nop 0
    v_cndmask_b32 v182, v133, v166, vcc
    v_cndmask_b32 v198, v136, v133, vcc
    v_cmp_le_i32 vcc, 7, v137
    s_waitcnt lgkmcnt(0)
    v_mfma_f32_32x32x16_bf16 v[80:95], v[16:19], v[224:227], v[80:95]
    ds_read_b64_tr_b16 v[48:49], v12 offset:49152
    ds_read_b64_tr_b16 v[50:51], v12 offset:49664
    ds_read_b64_tr_b16 v[52:53], v13 offset:49152
    ds_read_b64_tr_b16 v[54:55], v13 offset:49664
    v_mov_b32 v167, 0
    s_nop 0
    v_cndmask_b32 v183, v133, v167, vcc
    v_cndmask_b32 v199, v136, v133, vcc
    v_mfma_f32_32x32x16_bf16 v[96:111], v[20:23], v[224:227], v[96:111]
    ds_read_b64_tr_b16 v[56:57], v12 offset:51200
    ds_read_b64_tr_b16 v[58:59], v12 offset:51712
    ds_read_b64_tr_b16 v[60:61], v13 offset:51200
    ds_read_b64_tr_b16 v[62:63], v13 offset:51712
    v_cmp_le_i32 vcc, 16, v137
    v_mov_b32 v168, 0
    s_nop 0
    v_cndmask_b32 v184, v133, v168, vcc
    v_mfma_f32_32x32x16_bf16 v[80:95], v[24:27], v[228:231], v[80:95]
    ds_read_b64_tr_b16 v[64:65], v12 offset:53248
    ds_read_b64_tr_b16 v[66:67], v12 offset:53760
    ds_read_b64_tr_b16 v[68:69], v13 offset:53248
    ds_read_b64_tr_b16 v[70:71], v13 offset:53760
    v_cndmask_b32 v200, v136, v133, vcc
    v_cmp_le_i32 vcc, 17, v137
    v_mov_b32 v169, 0
    s_nop 0
    v_mfma_f32_32x32x16_bf16 v[96:111], v[28:31], v[228:231], v[96:111]
    ds_read_b64_tr_b16 v[72:73], v12 offset:55296
    ds_read_b64_tr_b16 v[74:75], v12 offset:55808
    ds_read_b64_tr_b16 v[76:77], v13 offset:55296
    ds_read_b64_tr_b16 v[78:79], v13 offset:55808
    v_cndmask_b32 v185, v133, v169, vcc
    v_cndmask_b32 v201, v136, v133, vcc
    v_cmp_le_i32 vcc, 18, v137
    v_mov_b32 v170, 0
    v_mfma_f32_32x32x16_bf16 v[80:95], v[32:35], v[232:235], v[80:95]
    s_nop 0
    v_cndmask_b32 v186, v133, v170, vcc
    v_cndmask_b32 v202, v136, v133, vcc
    v_cmp_le_i32 vcc, 19, v137
    v_mfma_f32_32x32x16_bf16 v[96:111], v[36:39], v[232:235], v[96:111]
    v_mov_b32 v171, 0
    s_nop 0
    v_cndmask_b32 v187, v133, v171, vcc
    v_cndmask_b32 v203, v136, v133, vcc
    v_mfma_f32_32x32x16_bf16 v[80:95], v[40:43], v[236:239], v[80:95]
    v_cmp_le_i32 vcc, 20, v137
    v_mov_b32 v172, 0
    s_nop 0
    v_cndmask_b32 v188, v133, v172, vcc
    v_mfma_f32_32x32x16_bf16 v[96:111], v[44:47], v[236:239], v[96:111]
    v_cndmask_b32 v204, v136, v133, vcc
    v_cmp_le_i32 vcc, 21, v137
    v_mov_b32 v173, 0
    s_nop 0
    s_waitcnt lgkmcnt(0)
    v_mfma_f32_32x32x16_bf16 v[80:95], v[48:51], v[240:243], v[80:95]
    v_cndmask_b32 v189, v133, v173, vcc
    v_cndmask_b32 v205, v136, v133, vcc
    v_cmp_le_i32 vcc, 22, v137
    v_mov_b32 v174, 0
    v_mfma_f32_32x32x16_bf16 v[96:111], v[52:55], v[240:243], v[96:111]
    s_nop 0
    v_cndmask_b32 v190, v133, v174, vcc
    v_cndmask_b32 v206, v136, v133, vcc
    v_cmp_le_i32 vcc, 23, v137
    v_mfma_f32_32x32x16_bf16 v[80:95], v[56:59], v[244:247], v[80:95]
    v_mov_b32 v175, 0
    s_nop 0
    v_cndmask_b32 v191, v133, v175, vcc
    v_cndmask_b32 v207, v136, v133, vcc
    v_mfma_f32_32x32x16_bf16 v[96:111], v[60:63], v[244:247], v[96:111]
    v_mfma_f32_32x32x16_bf16 v[80:95], v[64:67], v[248:251], v[80:95]
    v_mfma_f32_32x32x16_bf16 v[96:111], v[68:71], v[248:251], v[96:111]
    v_mfma_f32_32x32x16_bf16 v[80:95], v[72:75], v[252:255], v[80:95]
    v_mfma_f32_32x32x16_bf16 v[96:111], v[76:79], v[252:255], v[96:111]
    s_waitcnt vmcnt(0)
    s_lshl_b32 s62, s2, 7
    s_lshl_b32 s63, s56, 2
    s_add_u32 s62, s62, s63
    s_add_u32 s62, s62, 0x1008000
    v_mov_b32 v114, 1
    s_mov_b64 exec, 1
    buffer_store_dword v114, v14, s[36:39], s62 offen sc1
    s_mov_b64 exec, -1
    s_nop 10
    s_cmp_lt_u32 s69, 4
    s_cbranch_scc0 L_noscale2
    v_mul_f32 v80, s32, v80
    v_mul_f32 v81, s32, v81
    v_mul_f32 v82, s32, v82
    v_mul_f32 v83, s32, v83
    v_mul_f32 v84, s32, v84
    v_mul_f32 v85, s32, v85
    v_mul_f32 v86, s32, v86
    v_mul_f32 v87, s32, v87
    v_mul_f32 v88, s32, v88
    v_mul_f32 v89, s32, v89
    v_mul_f32 v90, s32, v90
    v_mul_f32 v91, s32, v91
    v_mul_f32 v92, s32, v92
    v_mul_f32 v93, s32, v93
    v_mul_f32 v94, s32, v94
    v_mul_f32 v95, s32, v95
    v_mul_f32 v96, s32, v96
    v_mul_f32 v97, s32, v97
    v_mul_f32 v98, s32, v98
    v_mul_f32 v99, s32, v99
    v_mul_f32 v100, s32, v100
    v_mul_f32 v101, s32, v101
    v_mul_f32 v102, s32, v102
    v_mul_f32 v103, s32, v103
    v_mul_f32 v104, s32, v104
    v_mul_f32 v105, s32, v105
    v_mul_f32 v106, s32, v106
    v_mul_f32 v107, s32, v107
    v_mul_f32 v108, s32, v108
    v_mul_f32 v109, s32, v109
    v_mul_f32 v110, s32, v110
    v_mul_f32 v111, s32, v111
L_noscale2:
    v_cvt_pk_bf16_f32 v208, v80, v81
    v_cvt_pk_bf16_f32 v209, v82, v83
    v_cvt_pk_bf16_f32 v210, v84, v85
    v_cvt_pk_bf16_f32 v211, v86, v87
    v_cvt_pk_bf16_f32 v212, v88, v89
    v_cvt_pk_bf16_f32 v213, v90, v91
    v_cvt_pk_bf16_f32 v214, v92, v93
    v_cvt_pk_bf16_f32 v215, v94, v95
    v_cvt_pk_bf16_f32 v216, v96, v97
    v_cvt_pk_bf16_f32 v217, v98, v99
    v_cvt_pk_bf16_f32 v218, v100, v101
    v_cvt_pk_bf16_f32 v219, v102, v103
    v_cvt_pk_bf16_f32 v220, v104, v105
    v_cvt_pk_bf16_f32 v221, v106, v107
    v_cvt_pk_bf16_f32 v222, v108, v109
    v_cvt_pk_bf16_f32 v223, v110, v111
    s_nop 1
    s_barrier
L_attn:
    ds_read_b128 v[116:119], v131
    ds_read_b128 v[16:19], v14 offset:0
    ds_read_b128 v[20:23], v14 offset:2048
    s_mov_b64 exec, s[22:23]
    ds_read_b128 v[144:147], v132 offset:0
    ds_read_b128 v[148:151], v132 offset:512
    s_mov_b64 exec, -1
    v_mov_b32 v131, v14
    s_waitcnt lgkmcnt(3)
    v_mfma_f32_32x32x16_bf16 v[32:47], v[16:19], v[116:119], 0
    s_lshl_b32 s19, s56, 13
    s_and_b32 s18, s19, 0x8000
    s_add_u32 s18, s18, s19
    s_add_u32 s18, s18, s21
    s_mov_b32 s9, 0
    s_mov_b32 s3, 0x1008000
    s_nop 5
    v_max3_f32 v134, v32, v33, v135
    v_max3_f32 v134, v34, v35, v134
    v_max3_f32 v134, v36, v37, v134
    v_max3_f32 v134, v38, v39, v134
    v_max3_f32 v134, v40, v41, v134
    v_max3_f32 v134, v42, v43, v134
    v_max3_f32 v134, v44, v45, v134
    v_max3_f32 v134, v46, v47, v134
    v_mov_b32 v133, v134
    s_nop 1
    v_permlane32_swap_b32 v134, v133
    v_max_f32 v134, v134, v133
    v_sub_f32 v64, 0, v134
    v_sub_f32 v65, 0, v134
    v_sub_f32 v66, 0, v134
    v_sub_f32 v67, 0, v134
    v_sub_f32 v68, 0, v134
    v_sub_f32 v69, 0, v134
    v_sub_f32 v70, 0, v134
    v_sub_f32 v71, 0, v134
    v_sub_f32 v72, 0, v134
    v_sub_f32 v73, 0, v134
    v_sub_f32 v74, 0, v134
    v_sub_f32 v75, 0, v134
    v_sub_f32 v76, 0, v134
    v_sub_f32 v77, 0, v134
    v_sub_f32 v78, 0, v134
    v_sub_f32 v79, 0, v134
    s_nop 1
    v_mfma_f32_32x32x16_bf16 v[32:47], v[16:19], v[116:119], v[64:79]
    s_waitcnt lgkmcnt(0)
    s_nop 9
    s_setprio 1
    v_exp_f32 v32, v32
    v_exp_f32 v33, v33
    s_waitcnt lgkmcnt(0)
    ds_read_b128 v[16:19], v131 offset:4096
    s_mov_b64 exec, s[22:23]
    ds_read_b128 v[152:155], v132 offset:2048
    ds_read_b128 v[156:159], v132 offset:2560
    s_mov_b64 exec, -1
    v_exp_f32 v34, v34
    v_exp_f32 v35, v35
    v_exp_f32 v36, v36
    v_mfma_f32_32x32x16_bf16 v[48:63], v[20:23], v[116:119], v[64:79]
    v_exp_f32 v37, v37
    v_exp_f32 v38, v38
    v_exp_f32 v39, v39
    v_exp_f32 v40, v40
    v_exp_f32 v41, v41
    v_smfmac_f32_32x32x32_bf16 v[160:175], v[144:147], v[32:39], v128
    v_exp_f32 v42, v42
    v_exp_f32 v43, v43
    s_setprio 0
    v_exp_f32 v44, v44
    v_exp_f32 v45, v45
    v_exp_f32 v46, v46
    v_exp_f32 v47, v47
    s_setprio 1
    v_exp_f32 v48, v48
    v_exp_f32 v49, v49
    v_smfmac_f32_32x32x32_bf16 v[160:175], v[148:151], v[40:47], v128
    s_waitcnt lgkmcnt(0)
    ds_read_b128 v[20:23], v131 offset:6144
    s_mov_b64 exec, s[22:23]
    ds_read_b128 v[144:147], v132 offset:4096
    ds_read_b128 v[148:151], v132 offset:4608
    s_mov_b64 exec, -1
    v_exp_f32 v50, v50
    v_exp_f32 v51, v51
    v_exp_f32 v52, v52
    v_mfma_f32_32x32x16_bf16 v[32:47], v[16:19], v[116:119], v[64:79]
    v_exp_f32 v53, v53
    v_exp_f32 v54, v54
    v_exp_f32 v55, v55
    v_exp_f32 v56, v56
    v_exp_f32 v57, v57
    v_smfmac_f32_32x32x32_bf16 v[160:175], v[152:155], v[48:55], v128
    v_exp_f32 v58, v58
    v_exp_f32 v59, v59
    s_setprio 0
    v_exp_f32 v60, v60
    v_exp_f32 v61, v61
    v_exp_f32 v62, v62
    v_exp_f32 v63, v63
    s_setprio 1
    v_exp_f32 v32, v32
    v_exp_f32 v33, v33
    v_smfmac_f32_32x32x32_bf16 v[160:175], v[156:159], v[56:63], v128
    s_waitcnt lgkmcnt(0)
    ds_read_b128 v[16:19], v131 offset:8192
    s_mov_b64 exec, s[22:23]
    ds_read_b128 v[152:155], v132 offset:6144
    ds_read_b128 v[156:159], v132 offset:6656
    s_mov_b64 exec, -1
    v_exp_f32 v34, v34
    v_exp_f32 v35, v35
    v_exp_f32 v36, v36
    v_mfma_f32_32x32x16_bf16 v[48:63], v[20:23], v[116:119], v[64:79]
    v_exp_f32 v37, v37
    v_exp_f32 v38, v38
    v_exp_f32 v39, v39
    v_exp_f32 v40, v40
    v_exp_f32 v41, v41
    v_smfmac_f32_32x32x32_bf16 v[160:175], v[144:147], v[32:39], v128
    v_exp_f32 v42, v42
    v_exp_f32 v43, v43
    s_setprio 0
    v_exp_f32 v44, v44
    v_exp_f32 v45, v45
    v_exp_f32 v46, v46
    v_exp_f32 v47, v47
    s_setprio 1
    v_exp_f32 v48, v48
    v_exp_f32 v49, v49
    v_smfmac_f32_32x32x32_bf16 v[160:175], v[148:151], v[40:47], v128
    s_waitcnt lgkmcnt(0)
    ds_read_b128 v[20:23], v131 offset:10240
    s_mov_b64 exec, s[22:23]
    ds_read_b128 v[144:147], v132 offset:8192
    ds_read_b128 v[148:151], v132 offset:8704
    s_mov_b64 exec, -1
    buffer_load_dwordx4 v[124:127], v138, s[36:39], s3 offen sc1
    v_exp_f32 v50, v50
    v_exp_f32 v51, v51
    v_exp_f32 v52, v52
    v_mfma_f32_32x32x16_bf16 v[32:47], v[16:19], v[116:119], v[64:79]
    v_exp_f32 v53, v53
    v_exp_f32 v54, v54
    v_exp_f32 v55, v55
    v_exp_f32 v56, v56
    v_exp_f32 v57, v57
    v_smfmac_f32_32x32x32_bf16 v[160:175], v[152:155], v[48:55], v128
    v_exp_f32 v58, v58
    v_exp_f32 v59, v59
    s_setprio 0
    v_exp_f32 v60, v60
    v_exp_f32 v61, v61
    v_exp_f32 v62, v62
    v_exp_f32 v63, v63
    s_setprio 1
    v_exp_f32 v32, v32
    v_exp_f32 v33, v33
    v_smfmac_f32_32x32x32_bf16 v[160:175], v[156:159], v[56:63], v128
    s_waitcnt lgkmcnt(0)
    ds_read_b128 v[16:19], v131 offset:12288
    s_mov_b64 exec, s[22:23]
    ds_read_b128 v[152:155], v132 offset:10240
    ds_read_b128 v[156:159], v132 offset:10752
    s_mov_b64 exec, -1
    v_exp_f32 v34, v34
    v_exp_f32 v35, v35
    v_exp_f32 v36, v36
    v_mfma_f32_32x32x16_bf16 v[48:63], v[20:23], v[116:119], v[64:79]
    v_exp_f32 v37, v37
    v_exp_f32 v38, v38
    v_exp_f32 v39, v39
    v_exp_f32 v40, v40
    v_exp_f32 v41, v41
    v_smfmac_f32_32x32x32_bf16 v[160:175], v[144:147], v[32:39], v128
    v_exp_f32 v42, v42
    v_exp_f32 v43, v43
    s_setprio 0
    v_exp_f32 v44, v44
    v_exp_f32 v45, v45
    v_exp_f32 v46, v46
    v_exp_f32 v47, v47
    s_setprio 1
    v_exp_f32 v48, v48
    v_exp_f32 v49, v49
    v_smfmac_f32_32x32x32_bf16 v[160:175], v[148:151], v[40:47], v128
    s_waitcnt lgkmcnt(0)
    ds_read_b128 v[20:23], v131 offset:14336
    s_mov_b64 exec, s[22:23]
    ds_read_b128 v[144:147], v132 offset:12288
    ds_read_b128 v[148:151], v132 offset:12800
    s_mov_b64 exec, -1
    v_exp_f32 v50, v50
    v_exp_f32 v51, v51
    v_exp_f32 v52, v52
    v_mfma_f32_32x32x16_bf16 v[32:47], v[16:19], v[116:119], v[64:79]
    v_exp_f32 v53, v53
    v_exp_f32 v54, v54
    v_exp_f32 v55, v55
    v_exp_f32 v56, v56
    v_exp_f32 v57, v57
    v_smfmac_f32_32x32x32_bf16 v[160:175], v[152:155], v[48:55], v128
    v_exp_f32 v58, v58
    v_exp_f32 v59, v59
    s_setprio 0
    v_exp_f32 v60, v60
    v_exp_f32 v61, v61
    v_exp_f32 v62, v62
    v_exp_f32 v63, v63
    s_setprio 1
    v_exp_f32 v32, v32
    v_exp_f32 v33, v33
    v_smfmac_f32_32x32x32_bf16 v[160:175], v[156:159], v[56:63], v128
    s_waitcnt lgkmcnt(0)
    ds_read_b128 v[16:19], v131 offset:16384
    s_mov_b64 exec, s[22:23]
    ds_read_b128 v[152:155], v132 offset:14336
    ds_read_b128 v[156:159], v132 offset:14848
    s_mov_b64 exec, -1
    s_mov_b32 s62, 131072
    s_branch L_chk4
L_spin4:
    buffer_load_dwordx4 v[124:127], v138, s[36:39], s3 offen sc1
L_chk4:
    s_waitcnt vmcnt(0)
    v_min3_u32 v124, v124, v125, v126
    v_min_u32 v124, v124, v127
    v_cmp_le_u32 vcc, 1, v124
    s_sub_u32 s62, s62, 1
    s_cbranch_scc1 L_ok4
    s_cmp_eq_u64 vcc, -1
    s_cbranch_scc0 L_spin4
L_ok4:
    s_barrier
    s_add_u32 m0, s19, 65536
    s_add_u32 s63, s18, 0
    buffer_load_dwordx4 v14, s[36:39], s63 offen sc1 lds
    v_exp_f32 v34, v34
    v_exp_f32 v35, v35
    v_exp_f32 v36, v36
    v_mfma_f32_32x32x16_bf16 v[48:63], v[20:23], v[116:119], v[64:79]
    v_exp_f32 v37, v37
    v_exp_f32 v38, v38
    v_exp_f32 v39, v39
    v_exp_f32 v40, v40
    v_exp_f32 v41, v41
    v_smfmac_f32_32x32x32_bf16 v[160:175], v[144:147], v[32:39], v128
    v_exp_f32 v42, v42
    v_exp_f32 v43, v43
    s_setprio 0
    v_exp_f32 v44, v44
    v_exp_f32 v45, v45
    v_exp_f32 v46, v46
    v_exp_f32 v47, v47
    s_setprio 1
    v_exp_f32 v48, v48
    v_exp_f32 v49, v49
    v_smfmac_f32_32x32x32_bf16 v[160:175], v[148:151], v[40:47], v128
    s_waitcnt lgkmcnt(0)
    ds_read_b128 v[20:23], v131 offset:18432
    s_mov_b64 exec, s[22:23]
    ds_read_b128 v[144:147], v132 offset:16384
    ds_read_b128 v[148:151], v132 offset:16896
    s_mov_b64 exec, -1
    s_add_u32 m0, s19, 66560
    s_add_u32 s63, s18, 1024
    buffer_load_dwordx4 v14, s[36:39], s63 offen sc1 lds
    v_exp_f32 v50, v50
    v_exp_f32 v51, v51
    v_exp_f32 v52, v52
    v_mfma_f32_32x32x16_bf16 v[32:47], v[16:19], v[116:119], v[64:79]
    v_exp_f32 v53, v53
    v_exp_f32 v54, v54
    v_exp_f32 v55, v55
    v_exp_f32 v56, v56
    v_exp_f32 v57, v57
    v_smfmac_f32_32x32x32_bf16 v[160:175], v[152:155], v[48:55], v128
    v_exp_f32 v58, v58
    v_exp_f32 v59, v59
    s_setprio 0
    v_exp_f32 v60, v60
    v_exp_f32 v61, v61
    v_exp_f32 v62, v62
    v_exp_f32 v63, v63
    s_setprio 1
    v_exp_f32 v32, v32
    v_exp_f32 v33, v33
    v_smfmac_f32_32x32x32_bf16 v[160:175], v[156:159], v[56:63], v128
    s_waitcnt lgkmcnt(0)
    ds_read_b128 v[16:19], v131 offset:20480
    s_mov_b64 exec, s[22:23]
    ds_read_b128 v[152:155], v132 offset:18432
    ds_read_b128 v[156:159], v132 offset:18944
    s_mov_b64 exec, -1
    s_add_u32 m0, s19, 67584
    s_add_u32 s63, s18, 2048
    buffer_load_dwordx4 v14, s[36:39], s63 offen sc1 lds
    v_exp_f32 v34, v34
    v_exp_f32 v35, v35
    v_exp_f32 v36, v36
    v_mfma_f32_32x32x16_bf16 v[48:63], v[20:23], v[116:119], v[64:79]
    v_exp_f32 v37, v37
    v_exp_f32 v38, v38
    v_exp_f32 v39, v39
    v_exp_f32 v40, v40
    v_exp_f32 v41, v41
    v_smfmac_f32_32x32x32_bf16 v[160:175], v[144:147], v[32:39], v128
    v_exp_f32 v42, v42
    v_exp_f32 v43, v43
    s_setprio 0
    v_exp_f32 v44, v44
    v_exp_f32 v45, v45
    v_exp_f32 v46, v46
    v_exp_f32 v47, v47
    s_setprio 1
    v_exp_f32 v48, v48
    v_exp_f32 v49, v49
    v_smfmac_f32_32x32x32_bf16 v[160:175], v[148:151], v[40:47], v128
    s_waitcnt lgkmcnt(0)
    ds_read_b128 v[20:23], v131 offset:22528
    s_mov_b64 exec, s[22:23]
    ds_read_b128 v[144:147], v132 offset:20480
    ds_read_b128 v[148:151], v132 offset:20992
    s_mov_b64 exec, -1
    s_add_u32 m0, s19, 68608
    s_add_u32 s63, s18, 3072
    buffer_load_dwordx4 v14, s[36:39], s63 offen sc1 lds
    v_exp_f32 v50, v50
    v_exp_f32 v51, v51
    v_exp_f32 v52, v52
    v_mfma_f32_32x32x16_bf16 v[32:47], v[16:19], v[116:119], v[64:79]
    v_exp_f32 v53, v53
    v_exp_f32 v54, v54
    v_exp_f32 v55, v55
    v_exp_f32 v56, v56
    v_exp_f32 v57, v57
    v_smfmac_f32_32x32x32_bf16 v[160:175], v[152:155], v[48:55], v128
    v_exp_f32 v58, v58
    v_exp_f32 v59, v59
    s_setprio 0
    v_exp_f32 v60, v60
    v_exp_f32 v61, v61
    v_exp_f32 v62, v62
    v_exp_f32 v63, v63
    s_setprio 1
    v_exp_f32 v32, v32
    v_exp_f32 v33, v33
    v_smfmac_f32_32x32x32_bf16 v[160:175], v[156:159], v[56:63], v128
    s_waitcnt lgkmcnt(0)
    ds_read_b128 v[16:19], v131 offset:24576
    s_mov_b64 exec, s[22:23]
    ds_read_b128 v[152:155], v132 offset:22528
    ds_read_b128 v[156:159], v132 offset:23040
    s_mov_b64 exec, -1
    s_add_u32 m0, s19, 69632
    s_add_u32 s63, s18, 4096
    buffer_load_dwordx4 v14, s[36:39], s63 offen sc1 lds
    v_exp_f32 v34, v34
    v_exp_f32 v35, v35
    v_exp_f32 v36, v36
    v_mfma_f32_32x32x16_bf16 v[48:63], v[20:23], v[116:119], v[64:79]
    v_exp_f32 v37, v37
    v_exp_f32 v38, v38
    v_exp_f32 v39, v39
    v_exp_f32 v40, v40
    v_exp_f32 v41, v41
    v_smfmac_f32_32x32x32_bf16 v[160:175], v[144:147], v[32:39], v128
    v_exp_f32 v42, v42
    v_exp_f32 v43, v43
    s_setprio 0
    v_exp_f32 v44, v44
    v_exp_f32 v45, v45
    v_exp_f32 v46, v46
    v_exp_f32 v47, v47
    s_setprio 1
    v_exp_f32 v48, v48
    v_exp_f32 v49, v49
    v_smfmac_f32_32x32x32_bf16 v[160:175], v[148:151], v[40:47], v128
    s_waitcnt lgkmcnt(0)
    ds_read_b128 v[20:23], v131 offset:26624
    s_mov_b64 exec, s[22:23]
    ds_read_b128 v[144:147], v132 offset:24576
    ds_read_b128 v[148:151], v132 offset:25088
    s_mov_b64 exec, -1
    s_add_u32 m0, s19, 70656
    s_add_u32 s63, s18, 5120
    buffer_load_dwordx4 v14, s[36:39], s63 offen sc1 lds
    v_exp_f32 v50, v50
    v_exp_f32 v51, v51
    v_exp_f32 v52, v52
    v_mfma_f32_32x32x16_bf16 v[32:47], v[16:19], v[116:119], v[64:79]
    v_exp_f32 v53, v53
    v_exp_f32 v54, v54
    v_exp_f32 v55, v55
    v_exp_f32 v56, v56
    v_exp_f32 v57, v57
    v_smfmac_f32_32x32x32_bf16 v[160:175], v[152:155], v[48:55], v128
    v_exp_f32 v58, v58
    v_exp_f32 v59, v59
    s_setprio 0
    v_exp_f32 v60, v60
    v_exp_f32 v61, v61
    v_exp_f32 v62, v62
    v_exp_f32 v63, v63
    s_setprio 1
    v_exp_f32 v32, v32
    v_exp_f32 v33, v33
    v_smfmac_f32_32x32x32_bf16 v[160:175], v[156:159], v[56:63], v128
    s_waitcnt lgkmcnt(0)
    ds_read_b128 v[16:19], v131 offset:28672
    s_mov_b64 exec, s[22:23]
    ds_read_b128 v[152:155], v132 offset:26624
    ds_read_b128 v[156:159], v132 offset:27136
    s_mov_b64 exec, -1
    s_add_u32 m0, s19, 71680
    s_add_u32 s63, s18, 6144
    buffer_load_dwordx4 v14, s[36:39], s63 offen sc1 lds
    v_exp_f32 v34, v34
    v_exp_f32 v35, v35
    v_exp_f32 v36, v36
    v_mfma_f32_32x32x16_bf16 v[48:63], v[20:23], v[116:119], v[64:79]
    v_exp_f32 v37, v37
    v_exp_f32 v38, v38
    v_exp_f32 v39, v39
    v_exp_f32 v40, v40
    v_exp_f32 v41, v41
    v_smfmac_f32_32x32x32_bf16 v[160:175], v[144:147], v[32:39], v128
    v_exp_f32 v42, v42
    v_exp_f32 v43, v43
    s_setprio 0
    v_exp_f32 v44, v44
    v_exp_f32 v45, v45
    v_exp_f32 v46, v46
    v_exp_f32 v47, v47
    s_setprio 1
    v_exp_f32 v48, v48
    v_exp_f32 v49, v49
    v_smfmac_f32_32x32x32_bf16 v[160:175], v[148:151], v[40:47], v128
    s_waitcnt lgkmcnt(0)
    ds_read_b128 v[20:23], v131 offset:30720
    s_mov_b64 exec, s[22:23]
    ds_read_b128 v[144:147], v132 offset:28672
    ds_read_b128 v[148:151], v132 offset:29184
    s_mov_b64 exec, -1
    s_add_u32 m0, s19, 72704
    s_add_u32 s63, s18, 7168
    buffer_load_dwordx4 v14, s[36:39], s63 offen sc1 lds
    v_exp_f32 v50, v50
    v_exp_f32 v51, v51
    v_exp_f32 v52, v52
    v_mfma_f32_32x32x16_bf16 v[32:47], v[16:19], v[116:119], v[64:79]
    v_exp_f32 v53, v53
    v_exp_f32 v54, v54
    v_exp_f32 v55, v55
    v_exp_f32 v56, v56
    v_exp_f32 v57, v57
    v_smfmac_f32_32x32x32_bf16 v[160:175], v[152:155], v[48:55], v128
    v_exp_f32 v58, v58
    v_exp_f32 v59, v59
    s_setprio 0
    v_exp_f32 v60, v60
    v_exp_f32 v61, v61
    v_exp_f32 v62, v62
    v_exp_f32 v63, v63
    s_setprio 1
    v_exp_f32 v32, v32
    v_exp_f32 v33, v33
    v_smfmac_f32_32x32x32_bf16 v[160:175], v[156:159], v[56:63], v128
    s_waitcnt lgkmcnt(0)
    ds_read_b128 v[16:19], v131 offset:32768
    s_mov_b64 exec, s[22:23]
    ds_read_b128 v[152:155], v132 offset:30720
    ds_read_b128 v[156:159], v132 offset:31232
    s_mov_b64 exec, -1
    v_mov_b32 v244, -1
    v_mov_b32 v245, -1
    v_mov_b32 v246, -1
    v_mov_b32 v247, -1
    s_add_u32 s62, s15, 32768
    buffer_store_dwordx4 v[244:247], v14, s[36:39], s15 offen sc1
    buffer_store_dwordx4 v[244:247], v14, s[36:39], s62 offen sc1
    v_exp_f32 v34, v34
    v_exp_f32 v35, v35
    v_exp_f32 v36, v36
    v_mfma_f32_32x32x16_bf16 v[48:63], v[20:23], v[116:119], v[64:79]
    v_exp_f32 v37, v37
    v_exp_f32 v38, v38
    v_exp_f32 v39, v39
    v_exp_f32 v40, v40
    v_exp_f32 v41, v41
    v_smfmac_f32_32x32x32_bf16 v[160:175], v[144:147], v[32:39], v128
    v_exp_f32 v42, v42
    v_exp_f32 v43, v43
    s_setprio 0
    v_exp_f32 v44, v44
    v_exp_f32 v45, v45
    v_exp_f32 v46, v46
    v_exp_f32 v47, v47
    s_setprio 1
    v_exp_f32 v48, v48
    v_exp_f32 v49, v49
    v_smfmac_f32_32x32x32_bf16 v[160:175], v[148:151], v[40:47], v128
    s_waitcnt lgkmcnt(0)
    ds_read_b128 v[20:23], v131 offset:34816
    s_mov_b64 exec, s[22:23]
    ds_read_b128 v[144:147], v132 offset:32768
    ds_read_b128 v[148:151], v132 offset:33280
    s_mov_b64 exec, -1
    s_cmp_ge_u32 s56, 4
    s_cbranch_scc1 L_nost3
    buffer_store_dwordx4 v[208:211], v5, s[36:39], s26 offen sc1
    s_add_u32 s26, s26, s27
    buffer_store_dwordx4 v[212:215], v5, s[36:39], s26 offen sc1
    s_add_u32 s26, s26, s27
    buffer_store_dwordx4 v[216:219], v5, s[36:39], s26 offen sc1
    s_add_u32 s26, s26, s27
    buffer_store_dwordx4 v[220:223], v5, s[36:39], s26 offen sc1
    s_add_u32 s26, s26, s27
L_nost3:
    v_exp_f32 v50, v50
    v_exp_f32 v51, v51
    v_exp_f32 v52, v52
    v_mfma_f32_32x32x16_bf16 v[32:47], v[16:19], v[116:119], v[64:79]
    v_exp_f32 v53, v53
    v_exp_f32 v54, v54
    v_exp_f32 v55, v55
    v_exp_f32 v56, v56
    v_exp_f32 v57, v57
    v_smfmac_f32_32x32x32_bf16 v[160:175], v[152:155], v[48:55], v128
    v_exp_f32 v58, v58
    v_exp_f32 v59, v59
    s_setprio 0
    v_exp_f32 v60, v60
    v_exp_f32 v61, v61
    v_exp_f32 v62, v62
    v_exp_f32 v63, v63
    s_setprio 1
    v_exp_f32 v32, v32
    v_exp_f32 v33, v33
    v_smfmac_f32_32x32x32_bf16 v[160:175], v[156:159], v[56:63], v128
    s_waitcnt lgkmcnt(0)
    ds_read_b128 v[16:19], v131 offset:36864
    s_mov_b64 exec, s[22:23]
    ds_read_b128 v[152:155], v132 offset:34816
    ds_read_b128 v[156:159], v132 offset:35328
    s_mov_b64 exec, -1
    v_exp_f32 v34, v34
    v_exp_f32 v35, v35
    v_exp_f32 v36, v36
    v_mfma_f32_32x32x16_bf16 v[48:63], v[20:23], v[116:119], v[64:79]
    v_exp_f32 v37, v37
    v_exp_f32 v38, v38
    v_exp_f32 v39, v39
    v_exp_f32 v40, v40
    v_exp_f32 v41, v41
    v_smfmac_f32_32x32x32_bf16 v[160:175], v[144:147], v[32:39], v128
    v_exp_f32 v42, v42
    v_exp_f32 v43, v43
    s_setprio 0
    v_exp_f32 v44, v44
    v_exp_f32 v45, v45
    v_exp_f32 v46, v46
    v_exp_f32 v47, v47
    s_setprio 1
    v_exp_f32 v48, v48
    v_exp_f32 v49, v49
    v_smfmac_f32_32x32x32_bf16 v[160:175], v[148:151], v[40:47], v128
    s_waitcnt lgkmcnt(0)
    ds_read_b128 v[20:23], v131 offset:38912
    s_mov_b64 exec, s[22:23]
    ds_read_b128 v[144:147], v132 offset:36864
    ds_read_b128 v[148:151], v132 offset:37376
    s_mov_b64 exec, -1
    v_exp_f32 v50, v50
    v_exp_f32 v51, v51
    v_exp_f32 v52, v52
    v_mfma_f32_32x32x16_bf16 v[32:47], v[16:19], v[116:119], v[64:79]
    v_exp_f32 v53, v53
    v_exp_f32 v54, v54
    v_exp_f32 v55, v55
    v_exp_f32 v56, v56
    v_exp_f32 v57, v57
    v_smfmac_f32_32x32x32_bf16 v[160:175], v[152:155], v[48:55], v128
    v_exp_f32 v58, v58
    v_exp_f32 v59, v59
    s_setprio 0
    v_exp_f32 v60, v60
    v_exp_f32 v61, v61
    v_exp_f32 v62, v62
    v_exp_f32 v63, v63
    s_setprio 1
    v_exp_f32 v32, v32
    v_exp_f32 v33, v33
    v_smfmac_f32_32x32x32_bf16 v[160:175], v[156:159], v[56:63], v128
    s_waitcnt lgkmcnt(0)
    ds_read_b128 v[16:19], v131 offset:40960
    s_mov_b64 exec, s[22:23]
    ds_read_b128 v[152:155], v132 offset:38912
    ds_read_b128 v[156:159], v132 offset:39424
    s_mov_b64 exec, -1
    v_exp_f32 v34, v34
    v_exp_f32 v35, v35
    v_exp_f32 v36, v36
    v_mfma_f32_32x32x16_bf16 v[48:63], v[20:23], v[116:119], v[64:79]
    v_exp_f32 v37, v37
    v_exp_f32 v38, v38
    v_exp_f32 v39, v39
    v_exp_f32 v40, v40
    v_exp_f32 v41, v41
    v_smfmac_f32_32x32x32_bf16 v[160:175], v[144:147], v[32:39], v128
    v_exp_f32 v42, v42
    v_exp_f32 v43, v43
    s_setprio 0
    v_exp_f32 v44, v44
    v_exp_f32 v45, v45
    v_exp_f32 v46, v46
    v_exp_f32 v47, v47
    s_setprio 1
    v_exp_f32 v48, v48
    v_exp_f32 v49, v49
    v_smfmac_f32_32x32x32_bf16 v[160:175], v[148:151], v[40:47], v128
    s_waitcnt lgkmcnt(0)
    ds_read_b128 v[20:23], v131 offset:43008
    s_mov_b64 exec, s[22:23]
    ds_read_b128 v[144:147], v132 offset:40960
    ds_read_b128 v[148:151], v132 offset:41472
    s_mov_b64 exec, -1
    v_exp_f32 v50, v50
    v_exp_f32 v51, v51
    v_exp_f32 v52, v52
    v_mfma_f32_32x32x16_bf16 v[32:47], v[16:19], v[116:119], v[64:79]
    v_exp_f32 v53, v53
    v_exp_f32 v54, v54
    v_exp_f32 v55, v55
    v_exp_f32 v56, v56
    v_exp_f32 v57, v57
    v_smfmac_f32_32x32x32_bf16 v[160:175], v[152:155], v[48:55], v128
    v_exp_f32 v58, v58
    v_exp_f32 v59, v59
    s_setprio 0
    v_exp_f32 v60, v60
    v_exp_f32 v61, v61
    v_exp_f32 v62, v62
    v_exp_f32 v63, v63
    s_setprio 1
    v_exp_f32 v32, v32
    v_exp_f32 v33, v33
    v_smfmac_f32_32x32x32_bf16 v[160:175], v[156:159], v[56:63], v128
    s_waitcnt lgkmcnt(0)
    ds_read_b128 v[16:19], v131 offset:45056
    s_mov_b64 exec, s[22:23]
    ds_read_b128 v[152:155], v132 offset:43008
    ds_read_b128 v[156:159], v132 offset:43520
    s_mov_b64 exec, -1
    v_exp_f32 v34, v34
    v_exp_f32 v35, v35
    v_exp_f32 v36, v36
    v_mfma_f32_32x32x16_bf16 v[48:63], v[20:23], v[116:119], v[64:79]
    v_exp_f32 v37, v37
    v_exp_f32 v38, v38
    v_exp_f32 v39, v39
    v_exp_f32 v40, v40
    v_exp_f32 v41, v41
    v_smfmac_f32_32x32x32_bf16 v[160:175], v[144:147], v[32:39], v128
    v_exp_f32 v42, v42
    v_exp_f32 v43, v43
    s_setprio 0
    v_exp_f32 v44, v44
    v_exp_f32 v45, v45
    v_exp_f32 v46, v46
    v_exp_f32 v47, v47
    s_setprio 1
    v_exp_f32 v48, v48
    v_exp_f32 v49, v49
    v_smfmac_f32_32x32x32_bf16 v[160:175], v[148:151], v[40:47], v128
    s_waitcnt lgkmcnt(0)
    ds_read_b128 v[20:23], v131 offset:47104
    s_mov_b64 exec, s[22:23]
    ds_read_b128 v[144:147], v132 offset:45056
    ds_read_b128 v[148:151], v132 offset:45568
    s_mov_b64 exec, -1
    v_exp_f32 v50, v50
    v_exp_f32 v51, v51
    v_exp_f32 v52, v52
    v_mfma_f32_32x32x16_bf16 v[32:47], v[16:19], v[116:119], v[64:79]
    v_exp_f32 v53, v53
    v_exp_f32 v54, v54
    v_exp_f32 v55, v55
    v_exp_f32 v56, v56
    v_exp_f32 v57, v57
    v_smfmac_f32_32x32x32_bf16 v[160:175], v[152:155], v[48:55], v128
    v_exp_f32 v58, v58
    v_exp_f32 v59, v59
    s_setprio 0
    v_exp_f32 v60, v60
    v_exp_f32 v61, v61
    v_exp_f32 v62, v62
    v_exp_f32 v63, v63
    s_setprio 1
    v_exp_f32 v32, v32
    v_exp_f32 v33, v33
    v_smfmac_f32_32x32x32_bf16 v[160:175], v[156:159], v[56:63], v128
    s_waitcnt lgkmcnt(0)
    ds_read_b128 v[16:19], v131 offset:49152
    s_mov_b64 exec, s[22:23]
    ds_read_b128 v[152:155], v132 offset:47104
    ds_read_b128 v[156:159], v132 offset:47616
    s_mov_b64 exec, -1
    s_waitcnt vmcnt(0)
    s_barrier
    s_and_b32 s62, s56, 3
    s_cbranch_scc0 L_t2x
L_t2r:
    v_exp_f32 v34, v34
    v_exp_f32 v35, v35
    v_exp_f32 v36, v36
    v_mfma_f32_32x32x16_bf16 v[48:63], v[20:23], v[116:119], v[64:79]
    v_exp_f32 v37, v37
    v_exp_f32 v38, v38
    v_exp_f32 v39, v39
    v_exp_f32 v40, v40
    v_exp_f32 v41, v41
    v_smfmac_f32_32x32x32_bf16 v[160:175], v[144:147], v[32:39], v128
    v_exp_f32 v42, v42
    v_exp_f32 v43, v43
    s_setprio 0
    v_exp_f32 v44, v44
    v_exp_f32 v45, v45
    v_exp_f32 v46, v46
    v_exp_f32 v47, v47
    s_setprio 1
    v_exp_f32 v48, v48
    v_exp_f32 v49, v49
    v_smfmac_f32_32x32x32_bf16 v[160:175], v[148:151], v[40:47], v128
    s_waitcnt lgkmcnt(0)
    ds_read_b128 v[20:23], v131 offset:51200
    s_mov_b64 exec, s[22:23]
    ds_read_b128 v[144:147], v132 offset:49152
    ds_read_b128 v[148:151], v132 offset:49664
    s_mov_b64 exec, -1
    s_lshl_b32 s19, s56, 12
    s_lshl_b32 s18, s56, 15
    s_lshl_b32 s62, s58, 7
    s_add_u32 s18, s18, s62
    v_exp_f32 v50, v50
    v_exp_f32 v51, v51
    v_exp_f32 v52, v52
    v_mfma_f32_32x32x16_bf16 v[32:47], v[16:19], v[116:119], v[64:79]
    v_exp_f32 v53, v53
    v_exp_f32 v54, v54
    v_exp_f32 v55, v55
    v_exp_f32 v56, v56
    v_exp_f32 v57, v57
    v_smfmac_f32_32x32x32_bf16 v[160:175], v[152:155], v[48:55], v128
    v_exp_f32 v58, v58
    v_exp_f32 v59, v59
    s_setprio 0
    v_exp_f32 v60, v60
    v_exp_f32 v61, v61
    v_exp_f32 v62, v62
    v_exp_f32 v63, v63
    s_setprio 1
    v_exp_f32 v32, v32
    v_exp_f32 v33, v33
    v_smfmac_f32_32x32x32_bf16 v[160:175], v[156:159], v[56:63], v128
    s_waitcnt lgkmcnt(0)
    ds_read_b128 v[16:19], v131 offset:53248
    s_mov_b64 exec, s[22:23]
    ds_read_b128 v[152:155], v132 offset:51200
    ds_read_b128 v[156:159], v132 offset:51712
    s_mov_b64 exec, -1
    v_exp_f32 v34, v34
    v_exp_f32 v35, v35
    v_exp_f32 v36, v36
    v_mfma_f32_32x32x16_bf16 v[48:63], v[20:23], v[116:119], v[64:79]
    v_exp_f32 v37, v37
    v_exp_f32 v38, v38
    v_exp_f32 v39, v39
    v_exp_f32 v40, v40
    v_exp_f32 v41, v41
    v_smfmac_f32_32x32x32_bf16 v[160:175], v[144:147], v[32:39], v128
    v_exp_f32 v42, v42
    v_exp_f32 v43, v43
    s_setprio 0
    v_exp_f32 v44, v44
    v_exp_f32 v45, v45
    v_exp_f32 v46, v46
    v_exp_f32 v47, v47
    s_setprio 1
    v_exp_f32 v48, v48
    v_exp_f32 v49, v49
    v_smfmac_f32_32x32x32_bf16 v[160:175], v[148:151], v[40:47], v128
    s_waitcnt lgkmcnt(0)
    ds_read_b128 v[20:23], v131 offset:55296
    s_mov_b64 exec, s[22:23]
    ds_read_b128 v[144:147], v132 offset:53248
    ds_read_b128 v[148:151], v132 offset:53760
    s_mov_b64 exec, -1
    v_exp_f32 v50, v50
    v_exp_f32 v51, v51
    v_exp_f32 v52, v52
    v_mfma_f32_32x32x16_bf16 v[32:47], v[16:19], v[116:119], v[64:79]
    v_exp_f32 v53, v53
    v_exp_f32 v54, v54
    v_exp_f32 v55, v55
    v_exp_f32 v56, v56
    v_exp_f32 v57, v57
    v_smfmac_f32_32x32x32_bf16 v[160:175], v[152:155], v[48:55], v128
    v_exp_f32 v58, v58
    v_exp_f32 v59, v59
    s_setprio 0
    v_exp_f32 v60, v60
    v_exp_f32 v61, v61
    v_exp_f32 v62, v62
    v_exp_f32 v63, v63
    s_setprio 1
    v_exp_f32 v32, v32
    v_exp_f32 v33, v33
    v_smfmac_f32_32x32x32_bf16 v[160:175], v[156:159], v[56:63], v128
    s_waitcnt lgkmcnt(0)
    ds_read_b128 v[16:19], v131 offset:57344
    s_mov_b64 exec, s[22:23]
    ds_read_b128 v[152:155], v132 offset:55296
    ds_read_b128 v[156:159], v132 offset:55808
    s_mov_b64 exec, -1
    v_exp_f32 v34, v34
    v_exp_f32 v35, v35
    v_exp_f32 v36, v36
    v_mfma_f32_32x32x16_bf16 v[48:63], v[20:23], v[116:119], v[64:79]
    v_exp_f32 v37, v37
    v_exp_f32 v38, v38
    v_exp_f32 v39, v39
    v_exp_f32 v40, v40
    v_exp_f32 v41, v41
    v_smfmac_f32_32x32x32_bf16 v[160:175], v[144:147], v[32:39], v128
    v_exp_f32 v42, v42
    v_exp_f32 v43, v43
    s_setprio 0
    v_exp_f32 v44, v44
    v_exp_f32 v45, v45
    v_exp_f32 v46, v46
    v_exp_f32 v47, v47
    s_setprio 1
    v_exp_f32 v48, v48
    v_exp_f32 v49, v49
    v_smfmac_f32_32x32x32_bf16 v[160:175], v[148:151], v[40:47], v128
    s_waitcnt lgkmcnt(0)
    ds_read_b128 v[20:23], v131 offset:59392
    s_mov_b64 exec, s[22:23]
    ds_read_b128 v[144:147], v132 offset:57344
    ds_read_b128 v[148:151], v132 offset:57856
    s_mov_b64 exec, -1
    v_exp_f32 v50, v50
    v_exp_f32 v51, v51
    v_exp_f32 v52, v52
    v_mfma_f32_32x32x16_bf16 v[32:47], v[16:19], v[116:119], v[64:79]
    v_exp_f32 v53, v53
    v_exp_f32 v54, v54
    v_exp_f32 v55, v55
    v_exp_f32 v56, v56
    v_exp_f32 v57, v57
    v_smfmac_f32_32x32x32_bf16 v[160:175], v[152:155], v[48:55], v128
    v_exp_f32 v58, v58
    v_exp_f32 v59, v59
    s_setprio 0
    v_exp_f32 v60, v60
    v_exp_f32 v61, v61
    v_exp_f32 v62, v62
    v_exp_f32 v63, v63
    s_setprio 1
    v_exp_f32 v32, v32
    v_exp_f32 v33, v33
    v_smfmac_f32_32x32x32_bf16 v[160:175], v[156:159], v[56:63], v128
    s_waitcnt lgkmcnt(0)
    ds_read_b128 v[16:19], v131 offset:61440
    s_mov_b64 exec, s[22:23]
    ds_read_b128 v[152:155], v132 offset:59392
    ds_read_b128 v[156:159], v132 offset:59904
    s_mov_b64 exec, -1
    v_exp_f32 v34, v34
    v_exp_f32 v35, v35
    v_exp_f32 v36, v36
    v_mfma_f32_32x32x16_bf16 v[48:63], v[20:23], v[116:119], v[64:79]
    v_exp_f32 v37, v37
    v_exp_f32 v38, v38
    v_exp_f32 v39, v39
    v_exp_f32 v40, v40
    v_exp_f32 v41, v41
    v_smfmac_f32_32x32x32_bf16 v[160:175], v[144:147], v[32:39], v128
    v_exp_f32 v42, v42
    v_exp_f32 v43, v43
    s_setprio 0
    v_exp_f32 v44, v44
    v_exp_f32 v45, v45
    v_exp_f32 v46, v46
    v_exp_f32 v47, v47
    s_setprio 1
    v_exp_f32 v48, v48
    v_exp_f32 v49, v49
    v_smfmac_f32_32x32x32_bf16 v[160:175], v[148:151], v[40:47], v128
    s_waitcnt lgkmcnt(0)
    ds_read_b128 v[20:23], v131 offset:63488
    s_mov_b64 exec, s[22:23]
    ds_read_b128 v[144:147], v132 offset:61440
    ds_read_b128 v[148:151], v132 offset:61952
    s_mov_b64 exec, -1
    v_exp_f32 v50, v50
    v_exp_f32 v51, v51
    v_exp_f32 v52, v52
    v_mfma_f32_32x32x16_bf16 v[32:47], v[16:19], v[116:119], v[64:79]
    v_exp_f32 v53, v53
    v_exp_f32 v54, v54
    v_exp_f32 v55, v55
    v_exp_f32 v56, v56
    v_exp_f32 v57, v57
    v_smfmac_f32_32x32x32_bf16 v[160:175], v[152:155], v[48:55], v128
    v_exp_f32 v58, v58
    v_exp_f32 v59, v59
    s_setprio 0
    v_exp_f32 v60, v60
    v_exp_f32 v61, v61
    v_exp_f32 v62, v62
    v_exp_f32 v63, v63
    v_add_u32 v131, 0x10000, v131
    s_setprio 1
    v_exp_f32 v32, v32
    v_exp_f32 v33, v33
    v_smfmac_f32_32x32x32_bf16 v[160:175], v[156:159], v[56:63], v128
    s_waitcnt lgkmcnt(0)
    ds_read_b128 v[16:19], v131 offset:0
    s_mov_b64 exec, s[22:23]
    ds_read_b128 v[152:155], v132 offset:63488
    ds_read_b128 v[156:159], v132 offset:64000
    s_mov_b64 exec, -1
    v_exp_f32 v34, v34
    v_exp_f32 v35, v35
    v_exp_f32 v36, v36
    v_mfma_f32_32x32x16_bf16 v[48:63], v[20:23], v[116:119], v[64:79]
    v_exp_f32 v37, v37
    v_exp_f32 v38, v38
    v_exp_f32 v39, v39
    v_exp_f32 v40, v40
    v_exp_f32 v41, v41
    v_smfmac_f32_32x32x32_bf16 v[160:175], v[144:147], v[32:39], v128
    v_exp_f32 v42, v42
    v_exp_f32 v43, v43
    s_setprio 0
    v_exp_f32 v44, v44
    v_exp_f32 v45, v45
    v_exp_f32 v46, v46
    v_exp_f32 v47, v47
    v_add_u32 v132, 0x10000, v132
    s_setprio 1
    v_exp_f32 v48, v48
    v_exp_f32 v49, v49
    v_smfmac_f32_32x32x32_bf16 v[160:175], v[148:151], v[40:47], v128
    s_waitcnt lgkmcnt(0)
    ds_read_b128 v[20:23], v131 offset:2048
    s_mov_b64 exec, s[22:23]
    ds_read_b128 v[144:147], v132 offset:0
    ds_read_b128 v[148:151], v132 offset:512
    s_mov_b64 exec, -1
    v_exp_f32 v50, v50
    v_exp_f32 v51, v51
    v_exp_f32 v52, v52
    v_mfma_f32_32x32x16_bf16 v[32:47], v[16:19], v[116:119], v[64:79]
    v_exp_f32 v53, v53
    v_exp_f32 v54, v54
    v_exp_f32 v55, v55
    v_exp_f32 v56, v56
    v_exp_f32 v57, v57
    v_smfmac_f32_32x32x32_bf16 v[160:175], v[152:155], v[48:55], v128
    v_exp_f32 v58, v58
    v_exp_f32 v59, v59
    s_setprio 0
    v_exp_f32 v60, v60
    v_exp_f32 v61, v61
    v_exp_f32 v62, v62
    v_exp_f32 v63, v63
    s_setprio 1
    v_exp_f32 v32, v32
    v_exp_f32 v33, v33
    v_smfmac_f32_32x32x32_bf16 v[160:175], v[156:159], v[56:63], v128
    s_waitcnt lgkmcnt(0)
    ds_read_b128 v[16:19], v131 offset:4096
    s_mov_b64 exec, s[22:23]
    ds_read_b128 v[152:155], v132 offset:2048
    ds_read_b128 v[156:159], v132 offset:2560
    s_mov_b64 exec, -1
    v_exp_f32 v34, v34
    v_exp_f32 v35, v35
    v_exp_f32 v36, v36
    v_mfma_f32_32x32x16_bf16 v[48:63], v[20:23], v[116:119], v[64:79]
    v_exp_f32 v37, v37
    v_exp_f32 v38, v38
    v_exp_f32 v39, v39
    v_exp_f32 v40, v40
    v_exp_f32 v41, v41
    v_smfmac_f32_32x32x32_bf16 v[160:175], v[144:147], v[32:39], v128
    v_exp_f32 v42, v42
    v_exp_f32 v43, v43
    s_setprio 0
    v_exp_f32 v44, v44
    v_exp_f32 v45, v45
    v_exp_f32 v46, v46
    v_exp_f32 v47, v47
    s_setprio 1
    v_exp_f32 v48, v48
    v_exp_f32 v49, v49
    v_smfmac_f32_32x32x32_bf16 v[160:175], v[148:151], v[40:47], v128
    s_waitcnt lgkmcnt(0)
    ds_read_b128 v[20:23], v131 offset:6144
    s_mov_b64 exec, s[22:23]
    ds_read_b128 v[144:147], v132 offset:4096
    ds_read_b128 v[148:151], v132 offset:4608
    s_mov_b64 exec, -1
    s_add_u32 m0, s19, 0
    s_add_u32 s63, s18, 0
    buffer_load_dwordx4 v139, s[40:43], s63 offen sc1 lds
    v_exp_f32 v50, v50
    v_exp_f32 v51, v51
    v_exp_f32 v52, v52
    v_mfma_f32_32x32x16_bf16 v[32:47], v[16:19], v[116:119], v[64:79]
    v_exp_f32 v53, v53
    v_exp_f32 v54, v54
    v_exp_f32 v55, v55
    v_exp_f32 v56, v56
    v_exp_f32 v57, v57
    v_smfmac_f32_32x32x32_bf16 v[160:175], v[152:155], v[48:55], v128
    v_exp_f32 v58, v58
    v_exp_f32 v59, v59
    s_setprio 0
    v_exp_f32 v60, v60
    v_exp_f32 v61, v61
    v_exp_f32 v62, v62
    v_exp_f32 v63, v63
    s_setprio 1
    v_exp_f32 v32, v32
    v_exp_f32 v33, v33
    v_smfmac_f32_32x32x32_bf16 v[160:175], v[156:159], v[56:63], v128
    s_waitcnt lgkmcnt(0)
    ds_read_b128 v[16:19], v131 offset:8192
    s_mov_b64 exec, s[22:23]
    ds_read_b128 v[152:155], v132 offset:6144
    ds_read_b128 v[156:159], v132 offset:6656
    s_mov_b64 exec, -1
    s_add_u32 m0, s19, 1024
    s_add_u32 s63, s18, 8192
    buffer_load_dwordx4 v139, s[40:43], s63 offen sc1 lds
    v_exp_f32 v34, v34
    v_exp_f32 v35, v35
    v_exp_f32 v36, v36
    v_mfma_f32_32x32x16_bf16 v[48:63], v[20:23], v[116:119], v[64:79]
    v_exp_f32 v37, v37
    v_exp_f32 v38, v38
    v_exp_f32 v39, v39
    v_exp_f32 v40, v40
    v_exp_f32 v41, v41
    v_smfmac_f32_32x32x32_bf16 v[160:175], v[144:147], v[32:39], v128
    v_exp_f32 v42, v42
    v_exp_f32 v43, v43
    s_setprio 0
    v_exp_f32 v44, v44
    v_exp_f32 v45, v45
    v_exp_f32 v46, v46
    v_exp_f32 v47, v47
    s_setprio 1
    v_exp_f32 v48, v48
    v_exp_f32 v49, v49
    v_smfmac_f32_32x32x32_bf16 v[160:175], v[148:151], v[40:47], v128
    s_waitcnt lgkmcnt(0)
    ds_read_b128 v[20:23], v131 offset:10240
    s_mov_b64 exec, s[22:23]
    ds_read_b128 v[144:147], v132 offset:8192
    ds_read_b128 v[148:151], v132 offset:8704
    s_mov_b64 exec, -1
    s_add_u32 m0, s19, 2048
    s_add_u32 s63, s18, 16384
    buffer_load_dwordx4 v139, s[40:43], s63 offen sc1 lds
    v_exp_f32 v50, v50
    v_exp_f32 v51, v51
    v_exp_f32 v52, v52
    v_mfma_f32_32x32x16_bf16 v[32:47], v[16:19], v[116:119], v[64:79]
    v_exp_f32 v53, v53
    v_exp_f32 v54, v54
    v_exp_f32 v55, v55
    v_exp_f32 v56, v56
    v_exp_f32 v57, v57
    v_smfmac_f32_32x32x32_bf16 v[160:175], v[152:155], v[48:55], v128
    v_exp_f32 v58, v58
    v_exp_f32 v59, v59
    s_setprio 0
    v_exp_f32 v60, v60
    v_exp_f32 v61, v61
    v_exp_f32 v62, v62
    v_exp_f32 v63, v63
    s_setprio 1
    v_exp_f32 v32, v32
    v_exp_f32 v33, v33
    v_smfmac_f32_32x32x32_bf16 v[160:175], v[156:159], v[56:63], v128
    s_waitcnt lgkmcnt(0)
    ds_read_b128 v[16:19], v131 offset:12288
    s_mov_b64 exec, s[22:23]
    ds_read_b128 v[152:155], v132 offset:10240
    ds_read_b128 v[156:159], v132 offset:10752
    s_mov_b64 exec, -1
    s_add_u32 m0, s19, 3072
    s_add_u32 s63, s18, 24576
    buffer_load_dwordx4 v139, s[40:43], s63 offen sc1 lds
    v_exp_f32 v34, v34
    v_exp_f32 v35, v35
    v_exp_f32 v36, v36
    v_mfma_f32_32x32x16_bf16 v[48:63], v[20:23], v[116:119], v[64:79]
    v_exp_f32 v37, v37
    v_exp_f32 v38, v38
    v_exp_f32 v39, v39
    v_exp_f32 v40, v40
    v_exp_f32 v41, v41
    v_smfmac_f32_32x32x32_bf16 v[160:175], v[144:147], v[32:39], v128
    v_exp_f32 v42, v42
    v_exp_f32 v43, v43
    s_setprio 0
    v_exp_f32 v44, v44
    v_exp_f32 v45, v45
    v_exp_f32 v46, v46
    v_exp_f32 v47, v47
    s_setprio 1
    v_exp_f32 v48, v48
    v_exp_f32 v49, v49
    v_smfmac_f32_32x32x32_bf16 v[160:175], v[148:151], v[40:47], v128
    s_waitcnt lgkmcnt(0)
    ds_read_b128 v[20:23], v131 offset:14336
    s_mov_b64 exec, s[22:23]
    ds_read_b128 v[144:147], v132 offset:12288
    ds_read_b128 v[148:151], v132 offset:12800
    s_mov_b64 exec, -1
    buffer_load_dword v124, v140, s[36:39], s10 offen sc1
    v_exp_f32 v50, v50
    v_exp_f32 v51, v51
    v_exp_f32 v52, v52
    v_mfma_f32_32x32x16_bf16 v[32:47], v[16:19], v[116:119], v[64:79]
    v_exp_f32 v53, v53
    v_exp_f32 v54, v54
    v_exp_f32 v55, v55
    v_exp_f32 v56, v56
    v_exp_f32 v57, v57
    v_smfmac_f32_32x32x32_bf16 v[160:175], v[152:155], v[48:55], v128
    v_exp_f32 v58, v58
    v_exp_f32 v59, v59
    s_setprio 0
    v_exp_f32 v60, v60
    v_exp_f32 v61, v61
    v_exp_f32 v62, v62
    v_exp_f32 v63, v63
    s_setprio 1
    v_exp_f32 v32, v32
    v_exp_f32 v33, v33
    v_smfmac_f32_32x32x32_bf16 v[160:175], v[156:159], v[56:63], v128
    s_waitcnt lgkmcnt(0)
    ds_read_b128 v[16:19], v131 offset:16384
    s_mov_b64 exec, s[22:23]
    ds_read_b128 v[152:155], v132 offset:14336
    ds_read_b128 v[156:159], v132 offset:14848
    s_mov_b64 exec, -1
    v_exp_f32 v34, v34
    v_exp_f32 v35, v35
    v_exp_f32 v36, v36
    v_mfma_f32_32x32x16_bf16 v[48:63], v[20:23], v[116:119], v[64:79]
    v_exp_f32 v37, v37
    v_exp_f32 v38, v38
    v_exp_f32 v39, v39
    v_exp_f32 v40, v40
    v_exp_f32 v41, v41
    v_smfmac_f32_32x32x32_bf16 v[160:175], v[144:147], v[32:39], v128
    v_exp_f32 v42, v42
    v_exp_f32 v43, v43
    s_setprio 0
    v_exp_f32 v44, v44
    v_exp_f32 v45, v45
    v_exp_f32 v46, v46
    v_exp_f32 v47, v47
    s_setprio 1
    v_exp_f32 v48, v48
    v_exp_f32 v49, v49
    v_smfmac_f32_32x32x32_bf16 v[160:175], v[148:151], v[40:47], v128
    s_waitcnt lgkmcnt(0)
    ds_read_b128 v[20:23], v131 offset:18432
    s_mov_b64 exec, s[22:23]
    ds_read_b128 v[144:147], v132 offset:16384
    ds_read_b128 v[148:151], v132 offset:16896
    s_mov_b64 exec, -1
    v_exp_f32 v50, v50
    v_exp_f32 v51, v51
    v_exp_f32 v52, v52
    v_mfma_f32_32x32x16_bf16 v[32:47], v[16:19], v[116:119], v[64:79]
    v_exp_f32 v53, v53
    v_exp_f32 v54, v54
    v_exp_f32 v55, v55
    v_exp_f32 v56, v56
    v_exp_f32 v57, v57
    v_smfmac_f32_32x32x32_bf16 v[160:175], v[152:155], v[48:55], v128
    v_exp_f32 v58, v58
    v_exp_f32 v59, v59
    s_setprio 0
    v_exp_f32 v60, v60
    v_exp_f32 v61, v61
    v_exp_f32 v62, v62
    v_exp_f32 v63, v63
    s_setprio 1
    v_exp_f32 v32, v32
    v_exp_f32 v33, v33
    v_smfmac_f32_32x32x32_bf16 v[160:175], v[156:159], v[56:63], v128
    s_waitcnt lgkmcnt(0)
    ds_read_b128 v[16:19], v131 offset:20480
    s_mov_b64 exec, s[22:23]
    ds_read_b128 v[152:155], v132 offset:18432
    ds_read_b128 v[156:159], v132 offset:18944
    s_mov_b64 exec, -1
    s_mov_b32 s62, 131072
    s_branch L_chk5
L_spin5:
    buffer_load_dword v124, v140, s[36:39], s10 offen sc1
L_chk5:
    s_waitcnt vmcnt(0)
    v_cmp_le_u32 vcc, 2, v124
    s_sub_u32 s62, s62, 1
    s_cbranch_scc1 L_ok5
    s_cmp_eq_u64 vcc, -1
    s_cbranch_scc0 L_spin5
L_ok5:
    s_lshl_b32 s12, s60, 14
    s_add_u32 s12, s12, s19
    s_cmp_lt_u32 s12, 16384
    s_cselect_b32 s62, 0, 16384
    s_add_u32 s12, s12, s13
    s_sub_u32 s12, s12, s62
    buffer_load_dwordx4 v[120:123], v14, s[36:39], s11 offen sc1
    v_and_b32 v140, 7, v1
    v_lshlrev_b32 v140, 10, v140
    s_add_u32 s10, s20, 32768
    v_exp_f32 v34, v34
    v_exp_f32 v35, v35
    v_exp_f32 v36, v36
    v_mfma_f32_32x32x16_bf16 v[48:63], v[20:23], v[116:119], v[64:79]
    v_exp_f32 v37, v37
    v_exp_f32 v38, v38
    v_exp_f32 v39, v39
    v_exp_f32 v40, v40
    v_exp_f32 v41, v41
    v_smfmac_f32_32x32x32_bf16 v[160:175], v[144:147], v[32:39], v128
    v_exp_f32 v42, v42
    v_exp_f32 v43, v43
    s_setprio 0
    v_exp_f32 v44, v44
    v_exp_f32 v45, v45
    v_exp_f32 v46, v46
    v_exp_f32 v47, v47
    s_setprio 1
    v_exp_f32 v48, v48
    v_exp_f32 v49, v49
    v_smfmac_f32_32x32x32_bf16 v[160:175], v[148:151], v[40:47], v128
    s_waitcnt lgkmcnt(0)
    ds_read_b128 v[20:23], v131 offset:22528
    s_mov_b64 exec, s[22:23]
    ds_read_b128 v[144:147], v132 offset:20480
    ds_read_b128 v[148:151], v132 offset:20992
    s_mov_b64 exec, -1
    s_add_u32 m0, s19, 131072
    s_add_u32 s63, s12, 0
    buffer_load_dwordx4 v14, s[36:39], s63 offen sc1 lds
    v_exp_f32 v50, v50
    v_exp_f32 v51, v51
    v_exp_f32 v52, v52
    v_mfma_f32_32x32x16_bf16 v[32:47], v[16:19], v[116:119], v[64:79]
    v_exp_f32 v53, v53
    v_exp_f32 v54, v54
    v_exp_f32 v55, v55
    v_exp_f32 v56, v56
    v_exp_f32 v57, v57
    v_smfmac_f32_32x32x32_bf16 v[160:175], v[152:155], v[48:55], v128
    v_exp_f32 v58, v58
    v_exp_f32 v59, v59
    s_setprio 0
    v_exp_f32 v60, v60
    v_exp_f32 v61, v61
    v_exp_f32 v62, v62
    v_exp_f32 v63, v63
    s_setprio 1
    v_exp_f32 v32, v32
    v_exp_f32 v33, v33
    v_smfmac_f32_32x32x32_bf16 v[160:175], v[156:159], v[56:63], v128
    s_waitcnt lgkmcnt(0)
    ds_read_b128 v[16:19], v131 offset:24576
    s_mov_b64 exec, s[22:23]
    ds_read_b128 v[152:155], v132 offset:22528
    ds_read_b128 v[156:159], v132 offset:23040
    s_mov_b64 exec, -1
    s_add_u32 m0, s19, 132096
    s_add_u32 s63, s12, 1024
    buffer_load_dwordx4 v14, s[36:39], s63 offen sc1 lds
    v_exp_f32 v34, v34
    v_exp_f32 v35, v35
    v_exp_f32 v36, v36
    v_mfma_f32_32x32x16_bf16 v[48:63], v[20:23], v[116:119], v[64:79]
    v_exp_f32 v37, v37
    v_exp_f32 v38, v38
    v_exp_f32 v39, v39
    v_exp_f32 v40, v40
    v_exp_f32 v41, v41
    v_smfmac_f32_32x32x32_bf16 v[160:175], v[144:147], v[32:39], v128
    v_exp_f32 v42, v42
    v_exp_f32 v43, v43
    s_setprio 0
    v_exp_f32 v44, v44
    v_exp_f32 v45, v45
    v_exp_f32 v46, v46
    v_exp_f32 v47, v47
    s_setprio 1
    v_exp_f32 v48, v48
    v_exp_f32 v49, v49
    v_smfmac_f32_32x32x32_bf16 v[160:175], v[148:151], v[40:47], v128
    s_waitcnt lgkmcnt(0)
    ds_read_b128 v[20:23], v131 offset:26624
    s_mov_b64 exec, s[22:23]
    ds_read_b128 v[144:147], v132 offset:24576
    ds_read_b128 v[148:151], v132 offset:25088
    s_mov_b64 exec, -1
    s_add_u32 m0, s19, 133120
    s_add_u32 s63, s12, 2048
    buffer_load_dwordx4 v14, s[36:39], s63 offen sc1 lds
    v_exp_f32 v50, v50
    v_exp_f32 v51, v51
    v_exp_f32 v52, v52
    v_mfma_f32_32x32x16_bf16 v[32:47], v[16:19], v[116:119], v[64:79]
    v_exp_f32 v53, v53
    v_exp_f32 v54, v54
    v_exp_f32 v55, v55
    v_exp_f32 v56, v56
    v_exp_f32 v57, v57
    v_smfmac_f32_32x32x32_bf16 v[160:175], v[152:155], v[48:55], v128
    v_exp_f32 v58, v58
    v_exp_f32 v59, v59
    s_setprio 0
    v_exp_f32 v60, v60
    v_exp_f32 v61, v61
    v_exp_f32 v62, v62
    v_exp_f32 v63, v63
    s_setprio 1
    v_exp_f32 v32, v32
    v_exp_f32 v33, v33
    v_smfmac_f32_32x32x32_bf16 v[160:175], v[156:159], v[56:63], v128
    s_waitcnt lgkmcnt(0)
    ds_read_b128 v[16:19], v131 offset:28672
    s_mov_b64 exec, s[22:23]
    ds_read_b128 v[152:155], v132 offset:26624
    ds_read_b128 v[156:159], v132 offset:27136
    s_mov_b64 exec, -1
    s_add_u32 m0, s19, 134144
    s_add_u32 s63, s12, 3072
    buffer_load_dwordx4 v14, s[36:39], s63 offen sc1 lds
    v_exp_f32 v34, v34
    v_exp_f32 v35, v35
    v_exp_f32 v36, v36
    v_mfma_f32_32x32x16_bf16 v[48:63], v[20:23], v[116:119], v[64:79]
    v_exp_f32 v37, v37
    v_exp_f32 v38, v38
    v_exp_f32 v39, v39
    v_exp_f32 v40, v40
    v_exp_f32 v41, v41
    v_smfmac_f32_32x32x32_bf16 v[160:175], v[144:147], v[32:39], v128
    v_exp_f32 v42, v42
    v_exp_f32 v43, v43
    s_setprio 0
    v_exp_f32 v44, v44
    v_exp_f32 v45, v45
    v_exp_f32 v46, v46
    v_exp_f32 v47, v47
    s_setprio 1
    v_exp_f32 v48, v48
    v_exp_f32 v49, v49
    v_smfmac_f32_32x32x32_bf16 v[160:175], v[148:151], v[40:47], v128
    s_waitcnt lgkmcnt(0)
    ds_read_b128 v[20:23], v131 offset:30720
    s_mov_b64 exec, s[22:23]
    ds_read_b128 v[144:147], v132 offset:28672
    ds_read_b128 v[148:151], v132 offset:29184
    s_mov_b64 exec, -1
    v_exp_f32 v50, v50
    v_exp_f32 v51, v51
    v_exp_f32 v52, v52
    v_mfma_f32_32x32x16_bf16 v[32:47], v[16:19], v[116:119], v[64:79]
    v_exp_f32 v53, v53
    v_exp_f32 v54, v54
    v_exp_f32 v55, v55
    v_exp_f32 v56, v56
    v_exp_f32 v57, v57
    v_smfmac_f32_32x32x32_bf16 v[160:175], v[152:155], v[48:55], v128
    v_exp_f32 v58, v58
    v_exp_f32 v59, v59
    s_setprio 0
    v_exp_f32 v60, v60
    v_exp_f32 v61, v61
    v_exp_f32 v62, v62
    v_exp_f32 v63, v63
    s_setprio 1
    v_exp_f32 v32, v32
    v_exp_f32 v33, v33
    v_smfmac_f32_32x32x32_bf16 v[160:175], v[156:159], v[56:63], v128
    s_waitcnt lgkmcnt(0)
    ds_read_b128 v[16:19], v131 offset:32768
    s_mov_b64 exec, s[22:23]
    ds_read_b128 v[152:155], v132 offset:30720
    ds_read_b128 v[156:159], v132 offset:31232
    s_mov_b64 exec, -1
    v_exp_f32 v34, v34
    v_exp_f32 v35, v35
    v_exp_f32 v36, v36
    v_mfma_f32_32x32x16_bf16 v[48:63], v[20:23], v[116:119], v[64:79]
    v_exp_f32 v37, v37
    v_exp_f32 v38, v38
    v_exp_f32 v39, v39
    v_exp_f32 v40, v40
    v_exp_f32 v41, v41
    v_smfmac_f32_32x32x32_bf16 v[160:175], v[144:147], v[32:39], v128
    v_exp_f32 v42, v42
    v_exp_f32 v43, v43
    s_setprio 0
    v_exp_f32 v44, v44
    v_exp_f32 v45, v45
    v_exp_f32 v46, v46
    v_exp_f32 v47, v47
    s_setprio 1
    v_exp_f32 v48, v48
    v_exp_f32 v49, v49
    v_smfmac_f32_32x32x32_bf16 v[160:175], v[148:151], v[40:47], v128
    s_waitcnt lgkmcnt(0)
    ds_read_b128 v[20:23], v131 offset:34816
    s_mov_b64 exec, s[22:23]
    ds_read_b128 v[144:147], v132 offset:32768
    ds_read_b128 v[148:151], v132 offset:33280
    s_mov_b64 exec, -1
    v_exp_f32 v50, v50
    v_exp_f32 v51, v51
    v_exp_f32 v52, v52
    v_mfma_f32_32x32x16_bf16 v[32:47], v[16:19], v[116:119], v[64:79]
    v_exp_f32 v53, v53
    v_exp_f32 v54, v54
    v_exp_f32 v55, v55
    v_exp_f32 v56, v56
    v_exp_f32 v57, v57
    v_smfmac_f32_32x32x32_bf16 v[160:175], v[152:155], v[48:55], v128
    v_exp_f32 v58, v58
    v_exp_f32 v59, v59
    s_setprio 0
    v_exp_f32 v60, v60
    v_exp_f32 v61, v61
    v_exp_f32 v62, v62
    v_exp_f32 v63, v63
    s_setprio 1
    v_exp_f32 v32, v32
    v_exp_f32 v33, v33
    v_smfmac_f32_32x32x32_bf16 v[160:175], v[156:159], v[56:63], v128
    s_waitcnt lgkmcnt(0)
    ds_read_b128 v[16:19], v131 offset:36864
    s_mov_b64 exec, s[22:23]
    ds_read_b128 v[152:155], v132 offset:34816
    ds_read_b128 v[156:159], v132 offset:35328
    s_mov_b64 exec, -1
    s_waitcnt vmcnt(0)
    s_barrier
    v_exp_f32 v34, v34
    v_exp_f32 v35, v35
    v_exp_f32 v36, v36
    v_mfma_f32_32x32x16_bf16 v[48:63], v[20:23], v[116:119], v[64:79]
    v_exp_f32 v37, v37
    v_exp_f32 v38, v38
    v_exp_f32 v39, v39
    v_exp_f32 v40, v40
    v_exp_f32 v41, v41
    v_smfmac_f32_32x32x32_bf16 v[160:175], v[144:147], v[32:39], v128
    v_exp_f32 v42, v42
    v_exp_f32 v43, v43
    s_setprio 0
    v_exp_f32 v44, v44
    v_exp_f32 v45, v45
    v_exp_f32 v46, v46
    v_exp_f32 v47, v47
    s_setprio 1
    v_exp_f32 v48, v48
    v_exp_f32 v49, v49
    v_smfmac_f32_32x32x32_bf16 v[160:175], v[148:151], v[40:47], v128
    s_waitcnt lgkmcnt(0)
    ds_read_b128 v[20:23], v131 offset:38912
    s_mov_b64 exec, s[22:23]
    ds_read_b128 v[144:147], v132 offset:36864
    ds_read_b128 v[148:151], v132 offset:37376
    s_mov_b64 exec, -1
    s_add_u32 m0, s19, 32768
    s_add_u32 s63, s18, 262144
    buffer_load_dwordx4 v139, s[40:43], s63 offen sc1 lds
    v_exp_f32 v50, v50
    v_exp_f32 v51, v51
    v_exp_f32 v52, v52
    v_mfma_f32_32x32x16_bf16 v[32:47], v[16:19], v[116:119], v[64:79]
    v_exp_f32 v53, v53
    v_exp_f32 v54, v54
    v_exp_f32 v55, v55
    v_exp_f32 v56, v56
    v_exp_f32 v57, v57
    v_smfmac_f32_32x32x32_bf16 v[160:175], v[152:155], v[48:55], v128
    v_exp_f32 v58, v58
    v_exp_f32 v59, v59
    s_setprio 0
    v_exp_f32 v60, v60
    v_exp_f32 v61, v61
    v_exp_f32 v62, v62
    v_exp_f32 v63, v63
    s_setprio 1
    v_exp_f32 v32, v32
    v_exp_f32 v33, v33
    v_smfmac_f32_32x32x32_bf16 v[160:175], v[156:159], v[56:63], v128
    s_waitcnt lgkmcnt(0)
    ds_read_b128 v[16:19], v131 offset:40960
    s_mov_b64 exec, s[22:23]
    ds_read_b128 v[152:155], v132 offset:38912
    ds_read_b128 v[156:159], v132 offset:39424
    s_mov_b64 exec, -1
    s_add_u32 m0, s19, 33792
    s_add_u32 s63, s18, 270336
    buffer_load_dwordx4 v139, s[40:43], s63 offen sc1 lds
    v_exp_f32 v34, v34
    v_exp_f32 v35, v35
    v_exp_f32 v36, v36
    v_mfma_f32_32x32x16_bf16 v[48:63], v[20:23], v[116:119], v[64:79]
    v_exp_f32 v37, v37
    v_exp_f32 v38, v38
    v_exp_f32 v39, v39
    v_exp_f32 v40, v40
    v_exp_f32 v41, v41
    v_smfmac_f32_32x32x32_bf16 v[160:175], v[144:147], v[32:39], v128
    v_exp_f32 v42, v42
    v_exp_f32 v43, v43
    s_setprio 0
    v_exp_f32 v44, v44
    v_exp_f32 v45, v45
    v_exp_f32 v46, v46
    v_exp_f32 v47, v47
    s_setprio 1
    v_exp_f32 v48, v48
    v_exp_f32 v49, v49
    v_smfmac_f32_32x32x32_bf16 v[160:175], v[148:151], v[40:47], v128
    s_waitcnt lgkmcnt(0)
    ds_read_b128 v[20:23], v131 offset:43008
    s_mov_b64 exec, s[22:23]
    ds_read_b128 v[144:147], v132 offset:40960
    ds_read_b128 v[148:151], v132 offset:41472
    s_mov_b64 exec, -1
    s_add_u32 m0, s19, 34816
    s_add_u32 s63, s18, 278528
    buffer_load_dwordx4 v139, s[40:43], s63 offen sc1 lds
    v_exp_f32 v50, v50
    v_exp_f32 v51, v51
    v_exp_f32 v52, v52
    v_mfma_f32_32x32x16_bf16 v[32:47], v[16:19], v[116:119], v[64:79]
    v_exp_f32 v53, v53
    v_exp_f32 v54, v54
    v_exp_f32 v55, v55
    v_exp_f32 v56, v56
    v_exp_f32 v57, v57
    v_smfmac_f32_32x32x32_bf16 v[160:175], v[152:155], v[48:55], v128
    v_exp_f32 v58, v58
    v_exp_f32 v59, v59
    s_setprio 0
    v_exp_f32 v60, v60
    v_exp_f32 v61, v61
    v_exp_f32 v62, v62
    v_exp_f32 v63, v63
    s_setprio 1
    v_exp_f32 v32, v32
    v_exp_f32 v33, v33
    v_smfmac_f32_32x32x32_bf16 v[160:175], v[156:159], v[56:63], v128
    s_waitcnt lgkmcnt(0)
    ds_read_b128 v[16:19], v131 offset:45056
    s_mov_b64 exec, s[22:23]
    ds_read_b128 v[152:155], v132 offset:43008
    ds_read_b128 v[156:159], v132 offset:43520
    s_mov_b64 exec, -1
    s_add_u32 m0, s19, 35840
    s_add_u32 s63, s18, 286720
    buffer_load_dwordx4 v139, s[40:43], s63 offen sc1 lds
    v_exp_f32 v34, v34
    v_exp_f32 v35, v35
    v_exp_f32 v36, v36
    v_mfma_f32_32x32x16_bf16 v[48:63], v[20:23], v[116:119], v[64:79]
    v_exp_f32 v37, v37
    v_exp_f32 v38, v38
    v_exp_f32 v39, v39
    v_exp_f32 v40, v40
    v_exp_f32 v41, v41
    v_smfmac_f32_32x32x32_bf16 v[160:175], v[144:147], v[32:39], v128
    v_exp_f32 v42, v42
    v_exp_f32 v43, v43
    s_setprio 0
    v_exp_f32 v44, v44
    v_exp_f32 v45, v45
    v_exp_f32 v46, v46
    v_exp_f32 v47, v47
    s_setprio 1
    v_exp_f32 v48, v48
    v_exp_f32 v49, v49
    v_smfmac_f32_32x32x32_bf16 v[160:175], v[148:151], v[40:47], v128
    s_waitcnt lgkmcnt(0)
    ds_read_b128 v[20:23], v131 offset:47104
    s_mov_b64 exec, s[22:23]
    ds_read_b128 v[144:147], v132 offset:45056
    ds_read_b128 v[148:151], v132 offset:45568
    s_mov_b64 exec, -1
    s_add_u32 m0, s19, 65536
    s_add_u32 s63, s18, 0
    buffer_load_dwordx4 v139, s[52:55], s63 offen sc1 lds
    v_exp_f32 v50, v50
    v_exp_f32 v51, v51
    v_exp_f32 v52, v52
    v_mfma_f32_32x32x16_bf16 v[32:47], v[16:19], v[116:119], v[64:79]
    v_exp_f32 v53, v53
    v_exp_f32 v54, v54
    v_exp_f32 v55, v55
    v_exp_f32 v56, v56
    v_exp_f32 v57, v57
    v_smfmac_f32_32x32x32_bf16 v[160:175], v[152:155], v[48:55], v128
    v_exp_f32 v58, v58
    v_exp_f32 v59, v59
    s_setprio 0
    v_exp_f32 v60, v60
    v_exp_f32 v61, v61
    v_exp_f32 v62, v62
    v_exp_f32 v63, v63
    s_setprio 1
    v_exp_f32 v32, v32
    v_exp_f32 v33, v33
    v_smfmac_f32_32x32x32_bf16 v[160:175], v[156:159], v[56:63], v128
    s_waitcnt lgkmcnt(0)
    ds_read_b128 v[16:19], v131 offset:49152
    s_mov_b64 exec, s[22:23]
    ds_read_b128 v[152:155], v132 offset:47104
    ds_read_b128 v[156:159], v132 offset:47616
    s_mov_b64 exec, -1
    s_add_u32 m0, s19, 66560
    s_add_u32 s63, s18, 8192
    buffer_load_dwordx4 v139, s[52:55], s63 offen sc1 lds
    v_exp_f32 v34, v34
    v_exp_f32 v35, v35
    v_exp_f32 v36, v36
    v_mfma_f32_32x32x16_bf16 v[48:63], v[20:23], v[116:119], v[64:79]
    v_exp_f32 v37, v37
    v_exp_f32 v38, v38
    v_exp_f32 v39, v39
    v_exp_f32 v40, v40
    v_exp_f32 v41, v41
    v_smfmac_f32_32x32x32_bf16 v[160:175], v[144:147], v[32:39], v128
    v_exp_f32 v42, v42
    v_exp_f32 v43, v43
    s_setprio 0
    v_exp_f32 v44, v44
    v_exp_f32 v45, v45
    v_exp_f32 v46, v46
    v_exp_f32 v47, v47
    s_setprio 1
    v_exp_f32 v48, v48
    v_exp_f32 v49, v49
    v_smfmac_f32_32x32x32_bf16 v[160:175], v[148:151], v[40:47], v128
    s_waitcnt lgkmcnt(0)
    ds_read_b128 v[20:23], v131 offset:51200
    s_mov_b64 exec, s[22:23]
    ds_read_b128 v[144:147], v132 offset:49152
    ds_read_b128 v[148:151], v132 offset:49664
    s_mov_b64 exec, -1
    s_add_u32 m0, s19, 67584
    s_add_u32 s63, s18, 16384
    buffer_load_dwordx4 v139, s[52:55], s63 offen sc1 lds
    v_exp_f32 v50, v50
    v_exp_f32 v51, v51
    v_exp_f32 v52, v52
    v_mfma_f32_32x32x16_bf16 v[32:47], v[16:19], v[116:119], v[64:79]
    v_exp_f32 v53, v53
    v_exp_f32 v54, v54
    v_exp_f32 v55, v55
    v_exp_f32 v56, v56
    v_exp_f32 v57, v57
    v_smfmac_f32_32x32x32_bf16 v[160:175], v[152:155], v[48:55], v128
    v_exp_f32 v58, v58
    v_exp_f32 v59, v59
    s_setprio 0
    v_exp_f32 v60, v60
    v_exp_f32 v61, v61
    v_exp_f32 v62, v62
    v_exp_f32 v63, v63
    s_setprio 1
    v_exp_f32 v32, v32
    v_exp_f32 v33, v33
    v_smfmac_f32_32x32x32_bf16 v[160:175], v[156:159], v[56:63], v128
    s_waitcnt lgkmcnt(0)
    ds_read_b128 v[16:19], v131 offset:53248
    s_mov_b64 exec, s[22:23]
    ds_read_b128 v[152:155], v132 offset:51200
    ds_read_b128 v[156:159], v132 offset:51712
    s_mov_b64 exec, -1
    s_add_u32 m0, s19, 68608
    s_add_u32 s63, s18, 24576
    buffer_load_dwordx4 v139, s[52:55], s63 offen sc1 lds
    v_exp_f32 v34, v34
    v_exp_f32 v35, v35
    v_exp_f32 v36, v36
    v_mfma_f32_32x32x16_bf16 v[48:63], v[20:23], v[116:119], v[64:79]
    v_exp_f32 v37, v37
    v_exp_f32 v38, v38
    v_exp_f32 v39, v39
    v_exp_f32 v40, v40
    v_exp_f32 v41, v41
    v_smfmac_f32_32x32x32_bf16 v[160:175], v[144:147], v[32:39], v128
    v_exp_f32 v42, v42
    v_exp_f32 v43, v43
    s_setprio 0
    v_exp_f32 v44, v44
    v_exp_f32 v45, v45
    v_exp_f32 v46, v46
    v_exp_f32 v47, v47
    s_setprio 1
    v_exp_f32 v48, v48
    v_exp_f32 v49, v49
    v_smfmac_f32_32x32x32_bf16 v[160:175], v[148:151], v[40:47], v128
    s_waitcnt lgkmcnt(0)
    ds_read_b128 v[20:23], v131 offset:55296
    s_mov_b64 exec, s[22:23]
    ds_read_b128 v[144:147], v132 offset:53248
    ds_read_b128 v[148:151], v132 offset:53760
    s_mov_b64 exec, -1
    v_exp_f32 v50, v50
    v_exp_f32 v51, v51
    v_exp_f32 v52, v52
    v_mfma_f32_32x32x16_bf16 v[32:47], v[16:19], v[116:119], v[64:79]
    v_exp_f32 v53, v53
    v_exp_f32 v54, v54
    v_exp_f32 v55, v55
    v_exp_f32 v56, v56
    v_exp_f32 v57, v57
    v_smfmac_f32_32x32x32_bf16 v[160:175], v[152:155], v[48:55], v128
    v_exp_f32 v58, v58
    v_exp_f32 v59, v59
    s_setprio 0
    v_exp_f32 v60, v60
    v_exp_f32 v61, v61
    v_exp_f32 v62, v62
    v_exp_f32 v63, v63
    s_setprio 1
    v_exp_f32 v32, v32
    v_exp_f32 v33, v33
    v_smfmac_f32_32x32x32_bf16 v[160:175], v[156:159], v[56:63], v128
    s_waitcnt lgkmcnt(0)
    ds_read_b128 v[16:19], v131 offset:57344
    s_mov_b64 exec, s[22:23]
    ds_read_b128 v[152:155], v132 offset:55296
    ds_read_b128 v[156:159], v132 offset:55808
    s_mov_b64 exec, -1
    v_exp_f32 v34, v34
    v_exp_f32 v35, v35
    v_exp_f32 v36, v36
    v_mfma_f32_32x32x16_bf16 v[48:63], v[20:23], v[116:119], v[64:79]
    v_exp_f32 v37, v37
    v_exp_f32 v38, v38
    v_exp_f32 v39, v39
    v_exp_f32 v40, v40
    v_exp_f32 v41, v41
    v_smfmac_f32_32x32x32_bf16 v[160:175], v[144:147], v[32:39], v128
    v_exp_f32 v42, v42
    v_exp_f32 v43, v43
    s_setprio 0
    v_exp_f32 v44, v44
    v_exp_f32 v45, v45
    v_exp_f32 v46, v46
    v_exp_f32 v47, v47
    s_setprio 1
    v_exp_f32 v48, v48
    v_exp_f32 v49, v49
    v_smfmac_f32_32x32x32_bf16 v[160:175], v[148:151], v[40:47], v128
    s_waitcnt lgkmcnt(0)
    ds_read_b128 v[20:23], v131 offset:59392
    s_mov_b64 exec, s[22:23]
    ds_read_b128 v[144:147], v132 offset:57344
    ds_read_b128 v[148:151], v132 offset:57856
    s_mov_b64 exec, -1
    v_exp_f32 v50, v50
    v_exp_f32 v51, v51
    v_exp_f32 v52, v52
    v_mfma_f32_32x32x16_bf16 v[32:47], v[16:19], v[116:119], v[64:79]
    v_exp_f32 v53, v53
    v_exp_f32 v54, v54
    v_exp_f32 v55, v55
    v_exp_f32 v56, v56
    v_exp_f32 v57, v57
    v_smfmac_f32_32x32x32_bf16 v[160:175], v[152:155], v[48:55], v128
    v_exp_f32 v58, v58
    v_exp_f32 v59, v59
    s_setprio 0
    v_exp_f32 v60, v60
    v_exp_f32 v61, v61
    v_exp_f32 v62, v62
    v_exp_f32 v63, v63
    s_setprio 1
    v_exp_f32 v32, v32
    v_exp_f32 v33, v33
    v_smfmac_f32_32x32x32_bf16 v[160:175], v[156:159], v[56:63], v128
    s_waitcnt lgkmcnt(0)
    ds_read_b128 v[16:19], v131 offset:61440
    s_mov_b64 exec, s[22:23]
    ds_read_b128 v[152:155], v132 offset:59392
    ds_read_b128 v[156:159], v132 offset:59904
    s_mov_b64 exec, -1
    v_exp_f32 v34, v34
    v_exp_f32 v35, v35
    v_exp_f32 v36, v36
    v_mfma_f32_32x32x16_bf16 v[48:63], v[20:23], v[116:119], v[64:79]
    v_exp_f32 v37, v37
    v_exp_f32 v38, v38
    v_exp_f32 v39, v39
    v_exp_f32 v40, v40
    v_exp_f32 v41, v41
    v_smfmac_f32_32x32x32_bf16 v[160:175], v[144:147], v[32:39], v128
    v_exp_f32 v42, v42
    v_exp_f32 v43, v43
    s_setprio 0
    v_exp_f32 v44, v44
    v_exp_f32 v45, v45
    v_exp_f32 v46, v46
    v_exp_f32 v47, v47
    s_setprio 1
    v_exp_f32 v48, v48
    v_exp_f32 v49, v49
    v_smfmac_f32_32x32x32_bf16 v[160:175], v[148:151], v[40:47], v128
    s_waitcnt lgkmcnt(0)
    ds_read_b128 v[20:23], v131 offset:63488
    s_mov_b64 exec, s[22:23]
    ds_read_b128 v[144:147], v132 offset:61440
    ds_read_b128 v[148:151], v132 offset:61952
    s_mov_b64 exec, -1
    v_exp_f32 v50, v50
    v_exp_f32 v51, v51
    v_exp_f32 v52, v52
    v_mfma_f32_32x32x16_bf16 v[32:47], v[16:19], v[116:119], v[64:79]
    v_exp_f32 v53, v53
    v_exp_f32 v54, v54
    v_exp_f32 v55, v55
    v_exp_f32 v56, v56
    v_exp_f32 v57, v57
    v_smfmac_f32_32x32x32_bf16 v[160:175], v[152:155], v[48:55], v128
    v_exp_f32 v58, v58
    v_exp_f32 v59, v59
    s_setprio 0
    v_exp_f32 v60, v60
    v_exp_f32 v61, v61
    v_exp_f32 v62, v62
    v_exp_f32 v63, v63
    s_setprio 1
    v_exp_f32 v32, v32
    v_exp_f32 v33, v33
    v_smfmac_f32_32x32x32_bf16 v[160:175], v[156:159], v[56:63], v128
    s_waitcnt lgkmcnt(0)
    s_mov_b64 exec, s[22:23]
    ds_read_b128 v[152:155], v132 offset:63488
    ds_read_b128 v[156:159], v132 offset:64000
    s_mov_b64 exec, -1
    v_exp_f32 v34, v34
    v_exp_f32 v35, v35
    v_exp_f32 v36, v36
    v_mfma_f32_32x32x16_bf16 v[48:63], v[20:23], v[116:119], v[64:79]
    v_exp_f32 v37, v37
    v_exp_f32 v38, v38
    v_exp_f32 v39, v39
    v_exp_f32 v40, v40
    v_exp_f32 v41, v41
    v_smfmac_f32_32x32x32_bf16 v[160:175], v[144:147], v[32:39], v128
    v_exp_f32 v42, v42
    v_exp_f32 v43, v43
    s_setprio 0
    v_exp_f32 v44, v44
    v_exp_f32 v45, v45
    v_exp_f32 v46, v46
    v_exp_f32 v47, v47
    s_setprio 1
    v_exp_f32 v48, v48
    v_exp_f32 v49, v49
    v_smfmac_f32_32x32x32_bf16 v[160:175], v[148:151], v[40:47], v128
    s_waitcnt lgkmcnt(0)
    v_exp_f32 v50, v50
    v_exp_f32 v51, v51
    v_exp_f32 v52, v52
    v_exp_f32 v53, v53
    v_exp_f32 v54, v54
    v_exp_f32 v55, v55
    v_exp_f32 v56, v56
    v_exp_f32 v57, v57
    v_smfmac_f32_32x32x32_bf16 v[160:175], v[152:155], v[48:55], v128
    v_exp_f32 v58, v58
    v_exp_f32 v59, v59
    s_setprio 0
    v_exp_f32 v60, v60
    v_exp_f32 v61, v61
    v_exp_f32 v62, v62
    v_exp_f32 v63, v63
    s_nop 1
    v_smfmac_f32_32x32x32_bf16 v[160:175], v[156:159], v[56:63], v128
L_B_fin:
    ds_read_b128 v[16:19], v129 offset:16384
    ds_read_b128 v[20:23], v129 offset:14336
    s_mov_b64 exec, s[22:23]
    ds_read_b128 v[144:147], v130 offset:16384
    ds_read_b128 v[148:151], v130 offset:16896
    s_mov_b64 exec, -1
    s_waitcnt lgkmcnt(3)
    v_mfma_f32_32x32x16_bf16 v[32:47], v[16:19], v[120:123], v[176:191]
    s_nop 4
    v_rcp_f32 v136, v168
    v_add_f32 v133, abs(v160), v168
    v_add_f32 v133, abs(v161), v133
    v_add_f32 v133, abs(v162), v133
    v_add_f32 v133, abs(v163), v133
    v_add_f32 v133, abs(v164), v133
    v_add_f32 v133, abs(v165), v133
    v_add_f32 v133, abs(v166), v133
    v_add_f32 v133, abs(v167), v133
    v_add_f32 v133, v136, v133
    v_cmp_gt_f32 vcc, 0x71800000, v133
    s_cmp_lg_u32 s8, 0
    s_cbranch_scc1 L_B_done
    s_cmp_eq_u64 vcc, -1
    s_cbranch_scc0 L_B_fb
L_B_done:
    v_mul_f32 v160, v136, v160
    v_mul_f32 v161, v136, v161
    v_mul_f32 v162, v136, v162
    v_mul_f32 v163, v136, v163
    v_mul_f32 v164, v136, v164
    v_mul_f32 v165, v136, v165
    v_mul_f32 v166, v136, v166
    v_mul_f32 v167, v136, v167
    v_cvt_pk_bf16_f32 v248, v160, v161
    v_cvt_pk_bf16_f32 v249, v162, v163
    v_cvt_pk_bf16_f32 v250, v164, v165
    v_cvt_pk_bf16_f32 v251, v166, v167
    v_min_u32 v248, -2, v248
    v_min_u32 v249, -2, v249
    v_min_u32 v250, -2, v250
    v_min_u32 v251, -2, v251
    s_add_u32 s62, s15, 32768
    buffer_store_dwordx4 v[248:251], v14, s[36:39], s62 offen sc1
    s_mov_b32 s8, 0
    v_mov_b32 v160, 0
    v_mov_b32 v161, 0
    v_mov_b32 v162, 0
    v_mov_b32 v163, 0
    v_mov_b32 v164, 0
    v_mov_b32 v165, 0
    v_mov_b32 v166, 0
    v_mov_b32 v167, 0
    v_mov_b32 v168, 0
L_A_max:
    v_max3_f32 v134, v32, v33, v135
    v_max3_f32 v134, v34, v35, v134
    v_max3_f32 v134, v36, v37, v134
    v_max3_f32 v134, v38, v39, v134
    v_max3_f32 v134, v40, v41, v134
    v_max3_f32 v134, v42, v43, v134
    v_max3_f32 v134, v44, v45, v134
    v_max3_f32 v134, v46, v47, v134
    v_mov_b32 v133, v134
    s_nop 1
    v_permlane32_swap_b32 v134, v133
    v_max_f32 v134, v134, v133
    v_sub_f32 v32, v32, v134
    v_sub_f32 v33, v33, v134
    v_sub_f32 v34, v34, v134
    v_sub_f32 v35, v35, v134
    v_sub_f32 v36, v36, v134
    v_sub_f32 v37, v37, v134
    v_sub_f32 v38, v38, v134
    v_sub_f32 v39, v39, v134
    v_sub_f32 v40, v40, v134
    v_sub_f32 v41, v41, v134
    v_sub_f32 v42, v42, v134
    v_sub_f32 v43, v43, v134
    v_sub_f32 v44, v44, v134
    v_sub_f32 v45, v45, v134
    v_sub_f32 v46, v46, v134
    v_sub_f32 v47, v47, v134
    v_sub_f32 v64, 0, v134
    v_sub_f32 v65, 0, v134
    v_sub_f32 v66, 0, v134
    v_sub_f32 v67, 0, v134
    v_sub_f32 v68, 0, v134
    v_sub_f32 v69, 0, v134
    v_sub_f32 v70, 0, v134
    v_sub_f32 v71, 0, v134
    v_sub_f32 v72, 0, v134
    v_sub_f32 v73, 0, v134
    v_sub_f32 v74, 0, v134
    v_sub_f32 v75, 0, v134
    v_sub_f32 v76, 0, v134
    v_sub_f32 v77, 0, v134
    v_sub_f32 v78, 0, v134
    v_sub_f32 v79, 0, v134
    v_sub_f32 v192, v192, v134
    v_sub_f32 v193, v193, v134
    v_sub_f32 v194, v194, v134
    v_sub_f32 v195, v195, v134
    v_sub_f32 v196, v196, v134
    v_sub_f32 v197, v197, v134
    v_sub_f32 v198, v198, v134
    v_sub_f32 v199, v199, v134
    v_sub_f32 v200, v200, v134
    v_sub_f32 v201, v201, v134
    v_sub_f32 v202, v202, v134
    v_sub_f32 v203, v203, v134
    v_sub_f32 v204, v204, v134
    v_sub_f32 v205, v205, v134
    v_sub_f32 v206, v206, v134
    v_sub_f32 v207, v207, v134
    s_setprio 3
    v_exp_f32 v32, v32
    v_exp_f32 v33, v33
    s_waitcnt lgkmcnt(0)
    ds_read_b128 v[16:19], v129 offset:12288
    s_mov_b64 exec, s[22:23]
    ds_read_b128 v[152:155], v130 offset:14336
    ds_read_b128 v[156:159], v130 offset:14848
    s_mov_b64 exec, -1
    s_barrier
    s_add_u32 m0, s19, 98304
    s_add_u32 s63, s18, 262144
    buffer_load_dwordx4 v139, s[52:55], s63 offen sc1 lds
    s_add_u32 m0, s19, 99328
    s_add_u32 s63, s18, 270336
    buffer_load_dwordx4 v139, s[52:55], s63 offen sc1 lds
L_A_x0:
    v_exp_f32 v34, v34
    v_exp_f32 v35, v35
    v_exp_f32 v36, v36
    s_cmp_eq_u32 s7, 0
    s_cbranch_scc1 L_A_off0
L_A_mid0:
    v_mfma_f32_32x32x16_bf16 v[48:63], v[20:23], v[120:123], v[64:79]
    v_exp_f32 v37, v37
    v_exp_f32 v38, v38
    v_exp_f32 v39, v39
    v_exp_f32 v40, v40
    v_exp_f32 v41, v41
    v_smfmac_f32_32x32x32_bf16 v[160:175], v[144:147], v[32:39], v128
    v_exp_f32 v42, v42
    v_exp_f32 v43, v43
    s_setprio 2
    v_exp_f32 v44, v44
    v_exp_f32 v45, v45
    v_exp_f32 v46, v46
    v_exp_f32 v47, v47
    s_setprio 3
    v_exp_f32 v48, v48
    v_exp_f32 v49, v49
    v_smfmac_f32_32x32x32_bf16 v[160:175], v[148:151], v[40:47], v128
    s_waitcnt lgkmcnt(0)
    ds_read_b128 v[20:23], v129 offset:10240
    s_mov_b64 exec, s[22:23]
    ds_read_b128 v[144:147], v130 offset:12288
    ds_read_b128 v[148:151], v130 offset:12800
    s_mov_b64 exec, -1
    s_add_u32 m0, s19, 100352
    s_add_u32 s63, s18, 278528
    buffer_load_dwordx4 v139, s[52:55], s63 offen sc1 lds
    s_add_u32 m0, s19, 101376
    s_add_u32 s63, s18, 286720
    buffer_load_dwordx4 v139, s[52:55], s63 offen sc1 lds
L_A_x1:
    v_exp_f32 v50, v50
    v_exp_f32 v51, v51
    v_exp_f32 v52, v52
    s_cmp_eq_u32 s7, 1
    s_cbranch_scc1 L_A_off1
L_A_mid1:
    v_mfma_f32_32x32x16_bf16 v[32:47], v[16:19], v[120:123], v[64:79]
    v_exp_f32 v53, v53
    v_exp_f32 v54, v54
    v_exp_f32 v55, v55
    v_exp_f32 v56, v56
    v_exp_f32 v57, v57
    v_smfmac_f32_32x32x32_bf16 v[160:175], v[152:155], v[48:55], v128
    v_exp_f32 v58, v58
    v_exp_f32 v59, v59
    s_setprio 2
    v_exp_f32 v60, v60
    v_exp_f32 v61, v61
    v_exp_f32 v62, v62
    v_exp_f32 v63, v63
    s_setprio 3
    v_exp_f32 v32, v32
    v_exp_f32 v33, v33
    v_smfmac_f32_32x32x32_bf16 v[160:175], v[156:159], v[56:63], v128
    s_waitcnt lgkmcnt(0)
    ds_read_b128 v[16:19], v129 offset:8192
    s_mov_b64 exec, s[22:23]
    ds_read_b128 v[152:155], v130 offset:10240
    ds_read_b128 v[156:159], v130 offset:10752
    s_mov_b64 exec, -1
    v_exp_f32 v34, v34
    v_exp_f32 v35, v35
    v_exp_f32 v36, v36
    s_cmp_eq_u32 s7, 2
    s_cbranch_scc1 L_A_off2
L_A_mid2:
    v_mfma_f32_32x32x16_bf16 v[48:63], v[20:23], v[120:123], v[64:79]
    v_exp_f32 v37, v37
    v_exp_f32 v38, v38
    v_exp_f32 v39, v39
    v_exp_f32 v40, v40
    v_exp_f32 v41, v41
    v_smfmac_f32_32x32x32_bf16 v[160:175], v[144:147], v[32:39], v128
    v_exp_f32 v42, v42
    v_exp_f32 v43, v43
    s_setprio 2
    v_exp_f32 v44, v44
    v_exp_f32 v45, v45
    v_exp_f32 v46, v46
    v_exp_f32 v47, v47
    s_setprio 2
    v_exp_f32 v48, v48
    v_exp_f32 v49, v49
    v_smfmac_f32_32x32x32_bf16 v[160:175], v[148:151], v[40:47], v128
    s_waitcnt lgkmcnt(0)
    ds_read_b128 v[20:23], v129 offset:6144
    s_mov_b64 exec, s[22:23]
    ds_read_b128 v[144:147], v130 offset:8192
    ds_read_b128 v[148:151], v130 offset:8704
    s_mov_b64 exec, -1
    v_exp_f32 v50, v50
    v_exp_f32 v51, v51
    v_exp_f32 v52, v52
    s_cmp_eq_u32 s7, 3
    s_cbranch_scc1 L_A_off3
L_A_mid3:
    v_mfma_f32_32x32x16_bf16 v[32:47], v[16:19], v[120:123], v[64:79]
    v_exp_f32 v53, v53
    v_exp_f32 v54, v54
    v_exp_f32 v55, v55
    v_exp_f32 v56, v56
    v_exp_f32 v57, v57
    v_smfmac_f32_32x32x32_bf16 v[160:175], v[152:155], v[48:55], v128
    v_exp_f32 v58, v58
    v_exp_f32 v59, v59
    s_setprio 1
    v_exp_f32 v60, v60
    v_exp_f32 v61, v61
    v_exp_f32 v62, v62
    v_exp_f32 v63, v63
    s_setprio 2
    v_exp_f32 v32, v32
    v_exp_f32 v33, v33
    v_smfmac_f32_32x32x32_bf16 v[160:175], v[156:159], v[56:63], v128
    s_waitcnt lgkmcnt(0)
    ds_read_b128 v[16:19], v129 offset:4096
    s_mov_b64 exec, s[22:23]
    ds_read_b128 v[152:155], v130 offset:6144
    ds_read_b128 v[156:159], v130 offset:6656
    s_mov_b64 exec, -1
    s_waitcnt vmcnt(0)
    s_barrier
    buffer_load_dword v124, v140, s[36:39], s10 offen sc1
L_A_x4:
    v_exp_f32 v34, v34
    v_exp_f32 v35, v35
    v_exp_f32 v36, v36
    s_cmp_eq_u32 s7, 4
    s_cbranch_scc1 L_A_off4
L_A_mid4:
    v_mfma_f32_32x32x16_bf16 v[48:63], v[20:23], v[120:123], v[64:79]
    v_exp_f32 v37, v37
    v_exp_f32 v38, v38
    v_exp_f32 v39, v39
    v_exp_f32 v40, v40
    v_exp_f32 v41, v41
    v_smfmac_f32_32x32x32_bf16 v[160:175], v[144:147], v[32:39], v128
    v_exp_f32 v42, v42
    v_exp_f32 v43, v43
    s_setprio 1
    v_exp_f32 v44, v44
    v_exp_f32 v45, v45
    v_exp_f32 v46, v46
    v_exp_f32 v47, v47
    s_setprio 2
    v_exp_f32 v48, v48
    v_exp_f32 v49, v49
    v_smfmac_f32_32x32x32_bf16 v[160:175], v[148:151], v[40:47], v128
    s_waitcnt lgkmcnt(0)
    ds_read_b128 v[20:23], v129 offset:2048
    s_mov_b64 exec, s[22:23]
    ds_read_b128 v[144:147], v130 offset:4096
    ds_read_b128 v[148:151], v130 offset:4608
    s_mov_b64 exec, -1
    v_exp_f32 v50, v50
    v_exp_f32 v51, v51
    v_exp_f32 v52, v52
    s_cmp_eq_u32 s7, 5
    s_cbranch_scc1 L_A_off5
L_A_mid5:
    v_mfma_f32_32x32x16_bf16 v[32:47], v[16:19], v[120:123], v[64:79]
    v_exp_f32 v53, v53
    v_exp_f32 v54, v54
    v_exp_f32 v55, v55
    v_exp_f32 v56, v56
    v_exp_f32 v57, v57
    v_smfmac_f32_32x32x32_bf16 v[160:175], v[152:155], v[48:55], v128
    v_exp_f32 v58, v58
    v_exp_f32 v59, v59
    s_setprio 1
    v_exp_f32 v60, v60
    v_exp_f32 v61, v61
    v_exp_f32 v62, v62
    v_exp_f32 v63, v63
    s_setprio 1
    v_exp_f32 v32, v32
    v_exp_f32 v33, v33
    v_smfmac_f32_32x32x32_bf16 v[160:175], v[156:159], v[56:63], v128
    s_waitcnt lgkmcnt(0)
    ds_read_b128 v[16:19], v129 offset:0
    s_mov_b64 exec, s[22:23]
    ds_read_b128 v[152:155], v130 offset:2048
    ds_read_b128 v[156:159], v130 offset:2560
    s_mov_b64 exec, -1
    s_waitcnt vmcnt(0)
    v_cmp_ne_u32 vcc, -1, v124
    v_mov_b32 v208, -1
    s_cmp_eq_u64 vcc, -1
    s_cbranch_scc0 L_A_x6
    s_add_u32 s62, s20, 32768
    s_add_u32 s63, s62, 4096
    buffer_load_dwordx4 v[208:211], v14, s[36:39], s62 offen offset:0 sc1
    buffer_load_dwordx4 v[212:215], v14, s[36:39], s62 offen offset:1024 sc1
    buffer_load_dwordx4 v[216:219], v14, s[36:39], s62 offen offset:2048 sc1
    buffer_load_dwordx4 v[220:223], v14, s[36:39], s62 offen offset:3072 sc1
    buffer_load_dwordx4 v[224:227], v14, s[36:39], s63 offen offset:0 sc1
    buffer_load_dwordx4 v[228:231], v14, s[36:39], s63 offen offset:1024 sc1
    buffer_load_dwordx4 v[232:235], v14, s[36:39], s63 offen offset:2048 sc1
    buffer_load_dwordx4 v[236:239], v14, s[36:39], s63 offen offset:3072 sc1
L_A_x6:
    v_exp_f32 v34, v34
    v_exp_f32 v35, v35
    v_exp_f32 v36, v36
    s_cmp_eq_u32 s7, 6
    s_cbranch_scc1 L_A_off6
L_A_mid6:
    v_mfma_f32_32x32x16_bf16 v[48:63], v[20:23], v[120:123], v[64:79]
    v_exp_f32 v37, v37
    v_exp_f32 v38, v38
    v_exp_f32 v39, v39
    v_exp_f32 v40, v40
    v_exp_f32 v41, v41
    v_smfmac_f32_32x32x32_bf16 v[160:175], v[144:147], v[32:39], v128
    v_exp_f32 v42, v42
    v_exp_f32 v43, v43
    s_setprio 0
    v_exp_f32 v44, v44
    v_exp_f32 v45, v45
    v_exp_f32 v46, v46
    v_exp_f32 v47, v47
    s_setprio 1
    v_exp_f32 v48, v48
    v_exp_f32 v49, v49
    v_smfmac_f32_32x32x32_bf16 v[160:175], v[148:151], v[40:47], v128
    s_waitcnt lgkmcnt(0)
    s_mov_b64 exec, s[22:23]
    ds_read_b128 v[144:147], v130 offset:0
    ds_read_b128 v[148:151], v130 offset:512
    s_mov_b64 exec, -1
    v_exp_f32 v50, v50
    v_exp_f32 v51, v51
    v_exp_f32 v52, v52
    v_mfma_f32_32x32x16_bf16 v[32:47], v[16:19], v[120:123], v[192:207]
    v_exp_f32 v53, v53
    v_exp_f32 v54, v54
    v_exp_f32 v55, v55
    v_exp_f32 v56, v56
    v_exp_f32 v57, v57
    v_smfmac_f32_32x32x32_bf16 v[160:175], v[152:155], v[48:55], v128
    v_exp_f32 v58, v58
    v_exp_f32 v59, v59
    s_setprio 0
    v_exp_f32 v60, v60
    v_exp_f32 v61, v61
    v_exp_f32 v62, v62
    v_exp_f32 v63, v63
    s_setprio 1
    v_exp_f32 v32, v32
    v_exp_f32 v33, v33
    v_smfmac_f32_32x32x32_bf16 v[160:175], v[156:159], v[56:63], v128
    s_waitcnt lgkmcnt(0)
    v_exp_f32 v34, v34
    v_exp_f32 v35, v35
    v_exp_f32 v36, v36
    v_exp_f32 v37, v37
    v_exp_f32 v38, v38
    v_exp_f32 v39, v39
    v_exp_f32 v40, v40
    v_exp_f32 v41, v41
    v_smfmac_f32_32x32x32_bf16 v[160:175], v[144:147], v[32:39], v128
    v_exp_f32 v42, v42
    v_exp_f32 v43, v43
    s_setprio 0
    v_exp_f32 v44, v44
    v_exp_f32 v45, v45
    v_exp_f32 v46, v46
    v_exp_f32 v47, v47
    s_nop 1
    v_smfmac_f32_32x32x32_bf16 v[160:175], v[148:151], v[40:47], v128
L_A_fin:
    s_nop 11
    v_rcp_f32 v136, v168
    v_add_f32 v133, abs(v160), v168
    v_add_f32 v133, abs(v161), v133
    v_add_f32 v133, abs(v162), v133
    v_add_f32 v133, abs(v163), v133
    v_add_f32 v133, abs(v164), v133
    v_add_f32 v133, abs(v165), v133
    v_add_f32 v133, abs(v166), v133
    v_add_f32 v133, abs(v167), v133
    v_add_f32 v133, v136, v133
    v_cmp_gt_f32 vcc, 0x71800000, v133
    s_cmp_lg_u32 s8, 0
    s_cbranch_scc1 L_A_done
    s_cmp_eq_u64 vcc, -1
    s_cbranch_scc0 L_A_fb
L_A_done:
    v_mul_f32 v160, v136, v160
    v_mul_f32 v161, v136, v161
    v_mul_f32 v162, v136, v162
    v_mul_f32 v163, v136, v163
    v_mul_f32 v164, v136, v164
    v_mul_f32 v165, v136, v165
    v_mul_f32 v166, v136, v166
    v_mul_f32 v167, v136, v167
    v_cvt_pk_bf16_f32 v244, v160, v161
    v_cvt_pk_bf16_f32 v245, v162, v163
    v_cvt_pk_bf16_f32 v246, v164, v165
    v_cvt_pk_bf16_f32 v247, v166, v167
    v_min_u32 v244, -2, v244
    v_min_u32 v245, -2, v245
    v_min_u32 v246, -2, v246
    v_min_u32 v247, -2, v247
    s_add_u32 s62, s15, 0
    buffer_store_dwordx4 v[244:247], v14, s[36:39], s62 offen sc1
    s_waitcnt vmcnt(1)
    ds_read_b64_tr_b16 v[144:145], v8 offset:0
    ds_read_b64_tr_b16 v[146:147], v8 offset:1024
    ds_read_b64_tr_b16 v[148:149], v9 offset:0
    ds_read_b64_tr_b16 v[150:151], v9 offset:1024
    ds_read_b64_tr_b16 v[152:153], v8 offset:2048
    ds_read_b64_tr_b16 v[154:155], v8 offset:3072
    ds_read_b64_tr_b16 v[156:157], v9 offset:2048
    ds_read_b64_tr_b16 v[158:159], v9 offset:3072
    ds_read_b64_tr_b16 v[160:161], v8 offset:4096
    ds_read_b64_tr_b16 v[162:163], v8 offset:5120
    ds_read_b64_tr_b16 v[164:165], v9 offset:4096
    ds_read_b64_tr_b16 v[166:167], v9 offset:5120
    ds_read_b64_tr_b16 v[168:169], v8 offset:6144
    ds_read_b64_tr_b16 v[170:171], v8 offset:7168
    ds_read_b64_tr_b16 v[172:173], v9 offset:6144
    ds_read_b64_tr_b16 v[174:175], v9 offset:7168
    ds_read_b64_tr_b16 v[176:177], v8 offset:8192
    ds_read_b64_tr_b16 v[178:179], v8 offset:9216
    ds_read_b64_tr_b16 v[180:181], v9 offset:8192
    ds_read_b64_tr_b16 v[182:183], v9 offset:9216
    ds_read_b64_tr_b16 v[184:185], v8 offset:10240
    ds_read_b64_tr_b16 v[186:187], v8 offset:11264
    ds_read_b64_tr_b16 v[188:189], v9 offset:10240
    ds_read_b64_tr_b16 v[190:191], v9 offset:11264
    ds_read_b64_tr_b16 v[192:193], v8 offset:12288
    ds_read_b64_tr_b16 v[194:195], v8 offset:13312
    ds_read_b64_tr_b16 v[196:197], v9 offset:12288
    ds_read_b64_tr_b16 v[198:199], v9 offset:13312
    ds_read_b64_tr_b16 v[200:201], v8 offset:14336
    ds_read_b64_tr_b16 v[202:203], v8 offset:15360
    ds_read_b64_tr_b16 v[204:205], v9 offset:14336
    ds_read_b64_tr_b16 v[206:207], v9 offset:15360
    v_max3_u32 v133, v208, v209, 0
    v_max3_u32 v133, v210, v211, v133
    v_max3_u32 v133, v212, v213, v133
    v_max3_u32 v133, v214, v215, v133
    v_max3_u32 v133, v216, v217, v133
    v_max3_u32 v133, v218, v219, v133
    v_max3_u32 v133, v220, v221, v133
    v_max3_u32 v133, v222, v223, v133
    v_max3_u32 v133, v224, v225, v133
    v_max3_u32 v133, v226, v227, v133
    v_max3_u32 v133, v228, v229, v133
    v_max3_u32 v133, v230, v231, v133
    v_max3_u32 v133, v232, v233, v133
    v_max3_u32 v133, v234, v235, v133
    v_max3_u32 v133, v236, v237, v133
    v_max3_u32 v133, v238, v239, v133
    v_cmp_ne_u32 vcc, -1, v133
    s_cmp_eq_u64 vcc, -1
    s_cbranch_scc0 L_OB_get
L_OB_ok:
    s_waitcnt lgkmcnt(15)
    v_mfma_f32_32x32x16_bf16 v[80:95], v[144:147], v[208:211], 0
    v_mfma_f32_32x32x16_bf16 v[96:111], v[148:151], v[208:211], 0
    s_waitcnt lgkmcnt(15)
    v_mfma_f32_32x32x16_bf16 v[80:95], v[152:155], v[212:215], v[80:95]
    v_mfma_f32_32x32x16_bf16 v[96:111], v[156:159], v[212:215], v[96:111]
    s_waitcnt lgkmcnt(15)
    v_mfma_f32_32x32x16_bf16 v[80:95], v[160:163], v[216:219], v[80:95]
    v_mfma_f32_32x32x16_bf16 v[96:111], v[164:167], v[216:219], v[96:111]
    s_waitcnt lgkmcnt(15)
    v_mfma_f32_32x32x16_bf16 v[80:95], v[168:171], v[220:223], v[80:95]
    v_mfma_f32_32x32x16_bf16 v[96:111], v[172:175], v[220:223], v[96:111]
    s_waitcnt lgkmcnt(12)
    v_mfma_f32_32x32x16_bf16 v[80:95], v[176:179], v[224:227], v[80:95]
    v_mfma_f32_32x32x16_bf16 v[96:111], v[180:183], v[224:227], v[96:111]
    s_waitcnt lgkmcnt(8)
    v_mfma_f32_32x32x16_bf16 v[80:95], v[184:187], v[228:231], v[80:95]
    v_mfma_f32_32x32x16_bf16 v[96:111], v[188:191], v[228:231], v[96:111]
    s_waitcnt lgkmcnt(4)
    v_mfma_f32_32x32x16_bf16 v[80:95], v[192:195], v[232:235], v[80:95]
    v_mfma_f32_32x32x16_bf16 v[96:111], v[196:199], v[232:235], v[96:111]
    s_waitcnt lgkmcnt(0)
    v_mfma_f32_32x32x16_bf16 v[80:95], v[200:203], v[236:239], v[80:95]
    v_mfma_f32_32x32x16_bf16 v[96:111], v[204:207], v[236:239], v[96:111]
    buffer_load_dword v124, v140, s[36:39], s20 offen sc1
    v_subrev_u32 v8, 0x10000, v8
    v_subrev_u32 v9, 0x10000, v9
    s_barrier
    ds_read_b64_tr_b16 v[144:145], v8 offset:0
    ds_read_b64_tr_b16 v[146:147], v8 offset:1024
    ds_read_b64_tr_b16 v[148:149], v9 offset:0
    ds_read_b64_tr_b16 v[150:151], v9 offset:1024
    ds_read_b64_tr_b16 v[152:153], v8 offset:2048
    ds_read_b64_tr_b16 v[154:155], v8 offset:3072
    ds_read_b64_tr_b16 v[156:157], v9 offset:2048
    ds_read_b64_tr_b16 v[158:159], v9 offset:3072
    ds_read_b64_tr_b16 v[160:161], v8 offset:4096
    ds_read_b64_tr_b16 v[162:163], v8 offset:5120
    ds_read_b64_tr_b16 v[164:165], v9 offset:4096
    ds_read_b64_tr_b16 v[166:167], v9 offset:5120
    ds_read_b64_tr_b16 v[168:169], v8 offset:6144
    ds_read_b64_tr_b16 v[170:171], v8 offset:7168
    ds_read_b64_tr_b16 v[172:173], v9 offset:6144
    ds_read_b64_tr_b16 v[174:175], v9 offset:7168
    ds_read_b64_tr_b16 v[176:177], v8 offset:8192
    ds_read_b64_tr_b16 v[178:179], v8 offset:9216
    ds_read_b64_tr_b16 v[180:181], v9 offset:8192
    ds_read_b64_tr_b16 v[182:183], v9 offset:9216
    ds_read_b64_tr_b16 v[184:185], v8 offset:10240
    ds_read_b64_tr_b16 v[186:187], v8 offset:11264
    ds_read_b64_tr_b16 v[188:189], v9 offset:10240
    ds_read_b64_tr_b16 v[190:191], v9 offset:11264
    ds_read_b64_tr_b16 v[192:193], v8 offset:12288
    ds_read_b64_tr_b16 v[194:195], v8 offset:13312
    ds_read_b64_tr_b16 v[196:197], v9 offset:12288
    ds_read_b64_tr_b16 v[198:199], v9 offset:13312
    ds_read_b64_tr_b16 v[200:201], v8 offset:14336
    ds_read_b64_tr_b16 v[202:203], v8 offset:15360
    ds_read_b64_tr_b16 v[204:205], v9 offset:14336
    ds_read_b64_tr_b16 v[206:207], v9 offset:15360
    s_mov_b32 s64, 131072
    s_branch L_chk6
L_spin6:
    buffer_load_dword v124, v140, s[36:39], s20 offen sc1
L_chk6:
    s_waitcnt vmcnt(0)
    v_cmp_ne_u32 vcc, -1, v124
    s_sub_u32 s64, s64, 1
    s_cbranch_scc1 L_ok6
    s_cmp_eq_u64 vcc, -1
    s_cbranch_scc0 L_spin6
L_ok6:
    s_add_u32 s62, s20, 0
    s_add_u32 s63, s62, 4096
    buffer_load_dwordx4 v[16:19], v14, s[36:39], s62 offen offset:0 sc1
    buffer_load_dwordx4 v[20:23], v14, s[36:39], s62 offen offset:1024 sc1
    buffer_load_dwordx4 v[24:27], v14, s[36:39], s62 offen offset:2048 sc1
    buffer_load_dwordx4 v[28:31], v14, s[36:39], s62 offen offset:3072 sc1
    buffer_load_dwordx4 v[32:35], v14, s[36:39], s63 offen offset:0 sc1
    buffer_load_dwordx4 v[36:39], v14, s[36:39], s63 offen offset:1024 sc1
    buffer_load_dwordx4 v[40:43], v14, s[36:39], s63 offen offset:2048 sc1
    buffer_load_dwordx4 v[44:47], v14, s[36:39], s63 offen offset:3072 sc1
    v_sub_f32 v133, 1.0, v112
    v_mul_f32 v80, v133, v80
    v_mul_f32 v81, v133, v81
    v_mul_f32 v82, v133, v82
    v_mul_f32 v83, v133, v83
    v_mul_f32 v84, v133, v84
    v_mul_f32 v85, v133, v85
    v_mul_f32 v86, v133, v86
    v_mul_f32 v87, v133, v87
    v_mul_f32 v88, v133, v88
    v_mul_f32 v89, v133, v89
    v_mul_f32 v90, v133, v90
    v_mul_f32 v91, v133, v91
    v_mul_f32 v92, v133, v92
    v_mul_f32 v93, v133, v93
    v_mul_f32 v94, v133, v94
    v_mul_f32 v95, v133, v95
    v_mul_f32 v96, v133, v96
    v_mul_f32 v97, v133, v97
    v_mul_f32 v98, v133, v98
    v_mul_f32 v99, v133, v99
    v_mul_f32 v100, v133, v100
    v_mul_f32 v101, v133, v101
    v_mul_f32 v102, v133, v102
    v_mul_f32 v103, v133, v103
    v_mul_f32 v104, v133, v104
    v_mul_f32 v105, v133, v105
    v_mul_f32 v106, v133, v106
    v_mul_f32 v107, v133, v107
    v_mul_f32 v108, v133, v108
    v_mul_f32 v109, v133, v109
    v_mul_f32 v110, v133, v110
    v_mul_f32 v111, v133, v111
    s_mov_b32 s64, 131072
    s_branch L_O_go
L_O_retry:
    s_add_u32 s62, s20, 0
    s_add_u32 s63, s62, 4096
    buffer_load_dwordx4 v[16:19], v14, s[36:39], s62 offen offset:0 sc1
    buffer_load_dwordx4 v[20:23], v14, s[36:39], s62 offen offset:1024 sc1
    buffer_load_dwordx4 v[24:27], v14, s[36:39], s62 offen offset:2048 sc1
    buffer_load_dwordx4 v[28:31], v14, s[36:39], s62 offen offset:3072 sc1
    buffer_load_dwordx4 v[32:35], v14, s[36:39], s63 offen offset:0 sc1
    buffer_load_dwordx4 v[36:39], v14, s[36:39], s63 offen offset:1024 sc1
    buffer_load_dwordx4 v[40:43], v14, s[36:39], s63 offen offset:2048 sc1
    buffer_load_dwordx4 v[44:47], v14, s[36:39], s63 offen offset:3072 sc1
L_O_go:
    s_waitcnt vmcnt(7) lgkmcnt(0)
    v_mfma_f32_32x32x16_bf16 v[48:63], v[144:147], v[16:19], 0
    v_mfma_f32_32x32x16_bf16 v[64:79], v[148:151], v[16:19], 0
    v_max3_u32 v133, v16, v17, 0
    v_max3_u32 v133, v18, v19, v133
    s_waitcnt vmcnt(6) lgkmcnt(0)
    v_mfma_f32_32x32x16_bf16 v[48:63], v[152:155], v[20:23], v[48:63]
    v_mfma_f32_32x32x16_bf16 v[64:79], v[156:159], v[20:23], v[64:79]
    v_max3_u32 v133, v20, v21, v133
    v_max3_u32 v133, v22, v23, v133
    s_waitcnt vmcnt(5) lgkmcnt(0)
    v_mfma_f32_32x32x16_bf16 v[48:63], v[160:163], v[24:27], v[48:63]
    v_mfma_f32_32x32x16_bf16 v[64:79], v[164:167], v[24:27], v[64:79]
    v_max3_u32 v133, v24, v25, v133
    v_max3_u32 v133, v26, v27, v133
    s_waitcnt vmcnt(4) lgkmcnt(0)
    v_mfma_f32_32x32x16_bf16 v[48:63], v[168:171], v[28:31], v[48:63]
    v_mfma_f32_32x32x16_bf16 v[64:79], v[172:175], v[28:31], v[64:79]
    v_max3_u32 v133, v28, v29, v133
    v_max3_u32 v133, v30, v31, v133
    s_waitcnt vmcnt(3) lgkmcnt(0)
    v_mfma_f32_32x32x16_bf16 v[48:63], v[176:179], v[32:35], v[48:63]
    v_mfma_f32_32x32x16_bf16 v[64:79], v[180:183], v[32:35], v[64:79]
    v_max3_u32 v133, v32, v33, v133
    v_max3_u32 v133, v34, v35, v133
    s_waitcnt vmcnt(2) lgkmcnt(0)
    v_mfma_f32_32x32x16_bf16 v[48:63], v[184:187], v[36:39], v[48:63]
    v_mfma_f32_32x32x16_bf16 v[64:79], v[188:191], v[36:39], v[64:79]
    v_max3_u32 v133, v36, v37, v133
    v_max3_u32 v133, v38, v39, v133
    s_waitcnt vmcnt(1) lgkmcnt(0)
    v_mfma_f32_32x32x16_bf16 v[48:63], v[192:195], v[40:43], v[48:63]
    v_mfma_f32_32x32x16_bf16 v[64:79], v[196:199], v[40:43], v[64:79]
    v_max3_u32 v133, v40, v41, v133
    v_max3_u32 v133, v42, v43, v133
    s_waitcnt vmcnt(0) lgkmcnt(0)
    v_mfma_f32_32x32x16_bf16 v[48:63], v[200:203], v[44:47], v[48:63]
    v_mfma_f32_32x32x16_bf16 v[64:79], v[204:207], v[44:47], v[64:79]
    v_max3_u32 v133, v44, v45, v133
    v_max3_u32 v133, v46, v47, v133
    v_cmp_ne_u32 vcc, -1, v133
    s_sub_u32 s64, s64, 1
    s_cbranch_scc1 L_O_ok
    s_cmp_eq_u64 vcc, -1
    s_cbranch_scc0 L_O_retry
L_O_ok:
    s_nop 6
    v_fmac_f32 v80, v112, v48
    v_fmac_f32 v81, v112, v49
    v_fmac_f32 v82, v112, v50
    v_fmac_f32 v83, v112, v51
    ds_write_b128 v2, v[80:83] offset:0
    v_fmac_f32 v84, v112, v52
    v_fmac_f32 v85, v112, v53
    v_fmac_f32 v86, v112, v54
    v_fmac_f32 v87, v112, v55
    ds_write_b128 v2, v[84:87] offset:1088
    v_fmac_f32 v88, v112, v56
    v_fmac_f32 v89, v112, v57
    v_fmac_f32 v90, v112, v58
    v_fmac_f32 v91, v112, v59
    ds_write_b128 v2, v[88:91] offset:2176
    v_fmac_f32 v92, v112, v60
    v_fmac_f32 v93, v112, v61
    v_fmac_f32 v94, v112, v62
    v_fmac_f32 v95, v112, v63
    ds_write_b128 v2, v[92:95] offset:3264
    v_fmac_f32 v96, v112, v64
    v_fmac_f32 v97, v112, v65
    v_fmac_f32 v98, v112, v66
    v_fmac_f32 v99, v112, v67
    ds_write_b128 v2, v[96:99] offset:4352
    v_fmac_f32 v100, v112, v68
    v_fmac_f32 v101, v112, v69
    v_fmac_f32 v102, v112, v70
    v_fmac_f32 v103, v112, v71
    ds_write_b128 v2, v[100:103] offset:5440
    v_fmac_f32 v104, v112, v72
    v_fmac_f32 v105, v112, v73
    v_fmac_f32 v106, v112, v74
    v_fmac_f32 v107, v112, v75
    ds_write_b128 v2, v[104:107] offset:6528
    v_fmac_f32 v108, v112, v76
    v_fmac_f32 v109, v112, v77
    v_fmac_f32 v110, v112, v78
    v_fmac_f32 v111, v112, v79
    ds_write_b128 v2, v[108:111] offset:7616
    s_waitcnt lgkmcnt(0)
    s_barrier
    ds_read_b128 v[16:19], v7 offset:0
    ds_read_b128 v[20:23], v7 offset:512
    ds_read_b128 v[24:27], v7 offset:17408
    ds_read_b128 v[28:31], v7 offset:17920
    ds_read_b128 v[32:35], v7 offset:34816
    ds_read_b128 v[36:39], v7 offset:35328
    ds_read_b128 v[40:43], v7 offset:52224
    ds_read_b128 v[44:47], v7 offset:52736
    s_waitcnt lgkmcnt(4)
    v_add_f32 v16, v16, v24
    v_add_f32 v17, v17, v25
    v_add_f32 v18, v18, v26
    v_add_f32 v19, v19, v27
    v_add_f32 v20, v20, v28
    v_add_f32 v21, v21, v29
    v_add_f32 v22, v22, v30
    v_add_f32 v23, v23, v31
    s_waitcnt lgkmcnt(0)
    v_add_f32 v32, v32, v40
    v_add_f32 v33, v33, v41
    v_add_f32 v34, v34, v42
    v_add_f32 v35, v35, v43
    v_add_f32 v36, v36, v44
    v_add_f32 v37, v37, v45
    v_add_f32 v38, v38, v46
    v_add_f32 v39, v39, v47
    v_add_f32 v16, v16, v32
    v_add_f32 v17, v17, v33
    v_add_f32 v18, v18, v34
    v_add_f32 v19, v19, v35
    v_add_f32 v20, v20, v36
    v_add_f32 v21, v21, v37
    v_add_f32 v22, v22, v38
    v_add_f32 v23, v23, v39
    v_cvt_pk_bf16_f32 v48, v16, v17
    v_cvt_pk_bf16_f32 v49, v18, v19
    v_cvt_pk_bf16_f32 v50, v20, v21
    v_cvt_pk_bf16_f32 v51, v22, v23
    buffer_store_dwordx4 v[48:51], v6, s[44:47], s33 offen sc1
L_end:
    s_endpgm
L_OB_get:
    buffer_load_dword v124, v140, s[36:39], s10 offen sc1
    s_mov_b32 s64, 131072
    s_branch L_chk7
L_spin7:
    buffer_load_dword v124, v140, s[36:39], s10 offen sc1
L_chk7:
    s_waitcnt vmcnt(0)
    v_cmp_ne_u32 vcc, -1, v124
    s_sub_u32 s64, s64, 1
    s_cbranch_scc1 L_ok7
    s_cmp_eq_u64 vcc, -1
    s_cbranch_scc0 L_spin7
L_ok7:
    s_mov_b32 s65, 131072
L_OB_retry:
    s_add_u32 s62, s20, 32768
    s_add_u32 s63, s62, 4096
    buffer_load_dwordx4 v[208:211], v14, s[36:39], s62 offen offset:0 sc1
    buffer_load_dwordx4 v[212:215], v14, s[36:39], s62 offen offset:1024 sc1
    buffer_load_dwordx4 v[216:219], v14, s[36:39], s62 offen offset:2048 sc1
    buffer_load_dwordx4 v[220:223], v14, s[36:39], s62 offen offset:3072 sc1
    buffer_load_dwordx4 v[224:227], v14, s[36:39], s63 offen offset:0 sc1
    buffer_load_dwordx4 v[228:231], v14, s[36:39], s63 offen offset:1024 sc1
    buffer_load_dwordx4 v[232:235], v14, s[36:39], s63 offen offset:2048 sc1
    buffer_load_dwordx4 v[236:239], v14, s[36:39], s63 offen offset:3072 sc1
    s_waitcnt vmcnt(0)
    v_max3_u32 v133, v208, v209, 0
    v_max3_u32 v133, v210, v211, v133
    v_max3_u32 v133, v212, v213, v133
    v_max3_u32 v133, v214, v215, v133
    v_max3_u32 v133, v216, v217, v133
    v_max3_u32 v133, v218, v219, v133
    v_max3_u32 v133, v220, v221, v133
    v_max3_u32 v133, v222, v223, v133
    v_max3_u32 v133, v224, v225, v133
    v_max3_u32 v133, v226, v227, v133
    v_max3_u32 v133, v228, v229, v133
    v_max3_u32 v133, v230, v231, v133
    v_max3_u32 v133, v232, v233, v133
    v_max3_u32 v133, v234, v235, v133
    v_max3_u32 v133, v236, v237, v133
    v_max3_u32 v133, v238, v239, v133
    v_cmp_ne_u32 vcc, -1, v133
    s_sub_u32 s65, s65, 1
    s_cbranch_scc1 L_OB_ok
    s_cmp_eq_u64 vcc, -1
    s_cbranch_scc0 L_OB_retry
    s_branch L_OB_ok
L_t2x:
    v_lshlrev_b32 v136, 10, v1
    s_and_b32 s64, s57, 7
    s_lshl_b32 s64, s64, 16
    s_lshl_b32 s63, s58, 7
    s_add_u32 s64, s64, s63
    s_cmp_eq_u32 s56, 0
    s_cbranch_scc0 L_t2y
    v_mov_b32 v133, 2
    s_lshl_b32 s62, s2, 7
    s_add_u32 s62, s62, 0x1000000
    s_mov_b64 exec, 1
    buffer_store_dword v133, v14, s[36:39], s62 offen sc1
    s_mov_b64 exec, -1
    buffer_load_dword v243, v136, s[40:43], s64 offen
    s_branch L_t2r
L_t2y:
    buffer_load_dword v243, v136, s[52:55], s64 offen
    s_branch L_t2r
L_A_off0:
    s_nop 7
    v_mov_b32 v64, s5
    v_mov_b32 v65, s5
    v_mov_b32 v66, s5
    v_mov_b32 v67, s5
    v_mov_b32 v68, s5
    v_mov_b32 v69, s5
    v_mov_b32 v70, s5
    v_mov_b32 v71, s5
    v_mov_b32 v72, s5
    v_mov_b32 v73, s5
    v_mov_b32 v74, s5
    v_mov_b32 v75, s5
    v_mov_b32 v76, s5
    v_mov_b32 v77, s5
    v_mov_b32 v78, s5
    v_mov_b32 v79, s5
    s_nop 1
    s_branch L_A_mid0
L_A_off1:
    s_nop 7
    v_mov_b32 v64, s5
    v_mov_b32 v65, s5
    v_mov_b32 v66, s5
    v_mov_b32 v67, s5
    v_mov_b32 v68, s5
    v_mov_b32 v69, s5
    v_mov_b32 v70, s5
    v_mov_b32 v71, s5
    v_mov_b32 v72, s5
    v_mov_b32 v73, s5
    v_mov_b32 v74, s5
    v_mov_b32 v75, s5
    v_mov_b32 v76, s5
    v_mov_b32 v77, s5
    v_mov_b32 v78, s5
    v_mov_b32 v79, s5
    s_nop 1
    s_branch L_A_mid1
L_A_off2:
    s_nop 7
    v_mov_b32 v64, s5
    v_mov_b32 v65, s5
    v_mov_b32 v66, s5
    v_mov_b32 v67, s5
    v_mov_b32 v68, s5
    v_mov_b32 v69, s5
    v_mov_b32 v70, s5
    v_mov_b32 v71, s5
    v_mov_b32 v72, s5
    v_mov_b32 v73, s5
    v_mov_b32 v74, s5
    v_mov_b32 v75, s5
    v_mov_b32 v76, s5
    v_mov_b32 v77, s5
    v_mov_b32 v78, s5
    v_mov_b32 v79, s5
    s_nop 1
    s_branch L_A_mid2
L_A_off3:
    s_nop 7
    v_mov_b32 v64, s5
    v_mov_b32 v65, s5
    v_mov_b32 v66, s5
    v_mov_b32 v67, s5
    v_mov_b32 v68, s5
    v_mov_b32 v69, s5
    v_mov_b32 v70, s5
    v_mov_b32 v71, s5
    v_mov_b32 v72, s5
    v_mov_b32 v73, s5
    v_mov_b32 v74, s5
    v_mov_b32 v75, s5
    v_mov_b32 v76, s5
    v_mov_b32 v77, s5
    v_mov_b32 v78, s5
    v_mov_b32 v79, s5
    s_nop 1
    s_branch L_A_mid3
L_A_off4:
    s_nop 7
    v_mov_b32 v64, s5
    v_mov_b32 v65, s5
    v_mov_b32 v66, s5
    v_mov_b32 v67, s5
    v_mov_b32 v68, s5
    v_mov_b32 v69, s5
    v_mov_b32 v70, s5
    v_mov_b32 v71, s5
    v_mov_b32 v72, s5
    v_mov_b32 v73, s5
    v_mov_b32 v74, s5
    v_mov_b32 v75, s5
    v_mov_b32 v76, s5
    v_mov_b32 v77, s5
    v_mov_b32 v78, s5
    v_mov_b32 v79, s5
    s_nop 1
    s_branch L_A_mid4
L_A_off5:
    s_nop 7
    v_mov_b32 v64, s5
    v_mov_b32 v65, s5
    v_mov_b32 v66, s5
    v_mov_b32 v67, s5
    v_mov_b32 v68, s5
    v_mov_b32 v69, s5
    v_mov_b32 v70, s5
    v_mov_b32 v71, s5
    v_mov_b32 v72, s5
    v_mov_b32 v73, s5
    v_mov_b32 v74, s5
    v_mov_b32 v75, s5
    v_mov_b32 v76, s5
    v_mov_b32 v77, s5
    v_mov_b32 v78, s5
    v_mov_b32 v79, s5
    s_nop 1
    s_branch L_A_mid5
L_A_off6:
    s_nop 7
    v_mov_b32 v64, s5
    v_mov_b32 v65, s5
    v_mov_b32 v66, s5
    v_mov_b32 v67, s5
    v_mov_b32 v68, s5
    v_mov_b32 v69, s5
    v_mov_b32 v70, s5
    v_mov_b32 v71, s5
    v_mov_b32 v72, s5
    v_mov_b32 v73, s5
    v_mov_b32 v74, s5
    v_mov_b32 v75, s5
    v_mov_b32 v76, s5
    v_mov_b32 v77, s5
    v_mov_b32 v78, s5
    v_mov_b32 v79, s5
    s_nop 1
    s_branch L_A_mid6
L_A_fb:
    s_waitcnt lgkmcnt(0)
    s_mov_b32 s8, 1
    v_mov_b32 v134, s5
    v_mov_b32 v160, 0
    v_mov_b32 v161, 0
    v_mov_b32 v162, 0
    v_mov_b32 v163, 0
    v_mov_b32 v164, 0
    v_mov_b32 v165, 0
    v_mov_b32 v166, 0
    v_mov_b32 v167, 0
    v_mov_b32 v168, 0
    v_mov_b32 v169, 0
    v_mov_b32 v170, 0
    v_mov_b32 v171, 0
    v_mov_b32 v172, 0
    v_mov_b32 v173, 0
    v_mov_b32 v174, 0
    v_mov_b32 v175, 0
    s_sub_u32 s17, 8, s56
    s_cmp_eq_u32 s60, 0
    s_cselect_b32 s17, s17, 0
L_A_fb0:
    s_lshl_b32 s62, s17, 11
    v_add_u32 v133, s62, v129
    ds_read_b128 v[16:19], v133 offset:0
    s_sub_u32 s62, 8, s17
    s_lshl_b32 s62, s62, 5
    v_add_u32 v136, s62, v137
    s_movk_i32 s62, 256
    s_waitcnt lgkmcnt(0)
    v_mfma_f32_32x32x16_bf16 v[32:47], v[16:19], v[120:123], 0
    s_nop 15
    v_subrev_u32 v133, 0, v136
    v_cmp_gt_u32 vcc, s62, v133
    s_nop 1
    v_cndmask_b32 v32, v135, v32, vcc
    v_max_f32 v134, v134, v32
    v_subrev_u32 v133, 1, v136
    v_cmp_gt_u32 vcc, s62, v133
    s_nop 1
    v_cndmask_b32 v33, v135, v33, vcc
    v_max_f32 v134, v134, v33
    v_subrev_u32 v133, 2, v136
    v_cmp_gt_u32 vcc, s62, v133
    s_nop 1
    v_cndmask_b32 v34, v135, v34, vcc
    v_max_f32 v134, v134, v34
    v_subrev_u32 v133, 3, v136
    v_cmp_gt_u32 vcc, s62, v133
    s_nop 1
    v_cndmask_b32 v35, v135, v35, vcc
    v_max_f32 v134, v134, v35
    v_subrev_u32 v133, 4, v136
    v_cmp_gt_u32 vcc, s62, v133
    s_nop 1
    v_cndmask_b32 v36, v135, v36, vcc
    v_max_f32 v134, v134, v36
    v_subrev_u32 v133, 5, v136
    v_cmp_gt_u32 vcc, s62, v133
    s_nop 1
    v_cndmask_b32 v37, v135, v37, vcc
    v_max_f32 v134, v134, v37
    v_subrev_u32 v133, 6, v136
    v_cmp_gt_u32 vcc, s62, v133
    s_nop 1
    v_cndmask_b32 v38, v135, v38, vcc
    v_max_f32 v134, v134, v38
    v_subrev_u32 v133, 7, v136
    v_cmp_gt_u32 vcc, s62, v133
    s_nop 1
    v_cndmask_b32 v39, v135, v39, vcc
    v_max_f32 v134, v134, v39
    v_subrev_u32 v133, 16, v136
    v_cmp_gt_u32 vcc, s62, v133
    s_nop 1
    v_cndmask_b32 v40, v135, v40, vcc
    v_max_f32 v134, v134, v40
    v_subrev_u32 v133, 17, v136
    v_cmp_gt_u32 vcc, s62, v133
    s_nop 1
    v_cndmask_b32 v41, v135, v41, vcc
    v_max_f32 v134, v134, v41
    v_subrev_u32 v133, 18, v136
    v_cmp_gt_u32 vcc, s62, v133
    s_nop 1
    v_cndmask_b32 v42, v135, v42, vcc
    v_max_f32 v134, v134, v42
    v_subrev_u32 v133, 19, v136
    v_cmp_gt_u32 vcc, s62, v133
    s_nop 1
    v_cndmask_b32 v43, v135, v43, vcc
    v_max_f32 v134, v134, v43
    v_subrev_u32 v133, 20, v136
    v_cmp_gt_u32 vcc, s62, v133
    s_nop 1
    v_cndmask_b32 v44, v135, v44, vcc
    v_max_f32 v134, v134, v44
    v_subrev_u32 v133, 21, v136
    v_cmp_gt_u32 vcc, s62, v133
    s_nop 1
    v_cndmask_b32 v45, v135, v45, vcc
    v_max_f32 v134, v134, v45
    v_subrev_u32 v133, 22, v136
    v_cmp_gt_u32 vcc, s62, v133
    s_nop 1
    v_cndmask_b32 v46, v135, v46, vcc
    v_max_f32 v134, v134, v46
    v_subrev_u32 v133, 23, v136
    v_cmp_gt_u32 vcc, s62, v133
    s_nop 1
    v_cndmask_b32 v47, v135, v47, vcc
    v_max_f32 v134, v134, v47
    s_add_u32 s17, s17, 1
    s_cmp_lt_u32 s17, 9
    s_cbranch_scc1 L_A_fb0
    v_mov_b32 v133, v134
    s_nop 1
    v_permlane32_swap_b32 v134, v133
    v_max_f32 v134, v134, v133
    s_sub_u32 s17, 8, s56
    s_cmp_eq_u32 s60, 0
    s_cselect_b32 s17, s17, 0
L_A_fb1:
    s_lshl_b32 s62, s17, 11
    v_add_u32 v133, s62, v129
    ds_read_b128 v[16:19], v133 offset:0
    v_add_u32 v133, s62, v130
    s_mov_b64 exec, s[22:23]
    ds_read_b128 v[144:147], v133 offset:0
    ds_read_b128 v[148:151], v133 offset:512
    s_mov_b64 exec, -1
    s_sub_u32 s62, 8, s17
    s_lshl_b32 s62, s62, 5
    v_add_u32 v136, s62, v137
    s_movk_i32 s62, 256
    s_waitcnt lgkmcnt(0)
    v_mfma_f32_32x32x16_bf16 v[32:47], v[16:19], v[120:123], 0
    s_nop 15
    v_subrev_u32 v133, 0, v136
    v_cmp_gt_u32 vcc, s62, v133
    v_sub_f32 v32, v32, v134
    s_nop 1
    v_cndmask_b32 v32, v135, v32, vcc
    v_exp_f32 v32, v32
    v_subrev_u32 v133, 1, v136
    v_cmp_gt_u32 vcc, s62, v133
    v_sub_f32 v33, v33, v134
    s_nop 1
    v_cndmask_b32 v33, v135, v33, vcc
    v_exp_f32 v33, v33
    v_subrev_u32 v133, 2, v136
    v_cmp_gt_u32 vcc, s62, v133
    v_sub_f32 v34, v34, v134
    s_nop 1
    v_cndmask_b32 v34, v135, v34, vcc
    v_exp_f32 v34, v34
    v_subrev_u32 v133, 3, v136
    v_cmp_gt_u32 vcc, s62, v133
    v_sub_f32 v35, v35, v134
    s_nop 1
    v_cndmask_b32 v35, v135, v35, vcc
    v_exp_f32 v35, v35
    v_subrev_u32 v133, 4, v136
    v_cmp_gt_u32 vcc, s62, v133
    v_sub_f32 v36, v36, v134
    s_nop 1
    v_cndmask_b32 v36, v135, v36, vcc
    v_exp_f32 v36, v36
    v_subrev_u32 v133, 5, v136
    v_cmp_gt_u32 vcc, s62, v133
    v_sub_f32 v37, v37, v134
    s_nop 1
    v_cndmask_b32 v37, v135, v37, vcc
    v_exp_f32 v37, v37
    v_subrev_u32 v133, 6, v136
    v_cmp_gt_u32 vcc, s62, v133
    v_sub_f32 v38, v38, v134
    s_nop 1
    v_cndmask_b32 v38, v135, v38, vcc
    v_exp_f32 v38, v38
    v_subrev_u32 v133, 7, v136
    v_cmp_gt_u32 vcc, s62, v133
    v_sub_f32 v39, v39, v134
    s_nop 1
    v_cndmask_b32 v39, v135, v39, vcc
    v_exp_f32 v39, v39
    v_subrev_u32 v133, 16, v136
    v_cmp_gt_u32 vcc, s62, v133
    v_sub_f32 v40, v40, v134
    s_nop 1
    v_cndmask_b32 v40, v135, v40, vcc
    v_exp_f32 v40, v40
    v_subrev_u32 v133, 17, v136
    v_cmp_gt_u32 vcc, s62, v133
    v_sub_f32 v41, v41, v134
    s_nop 1
    v_cndmask_b32 v41, v135, v41, vcc
    v_exp_f32 v41, v41
    v_subrev_u32 v133, 18, v136
    v_cmp_gt_u32 vcc, s62, v133
    v_sub_f32 v42, v42, v134
    s_nop 1
    v_cndmask_b32 v42, v135, v42, vcc
    v_exp_f32 v42, v42
    v_subrev_u32 v133, 19, v136
    v_cmp_gt_u32 vcc, s62, v133
    v_sub_f32 v43, v43, v134
    s_nop 1
    v_cndmask_b32 v43, v135, v43, vcc
    v_exp_f32 v43, v43
    v_subrev_u32 v133, 20, v136
    v_cmp_gt_u32 vcc, s62, v133
    v_sub_f32 v44, v44, v134
    s_nop 1
    v_cndmask_b32 v44, v135, v44, vcc
    v_exp_f32 v44, v44
    v_subrev_u32 v133, 21, v136
    v_cmp_gt_u32 vcc, s62, v133
    v_sub_f32 v45, v45, v134
    s_nop 1
    v_cndmask_b32 v45, v135, v45, vcc
    v_exp_f32 v45, v45
    v_subrev_u32 v133, 22, v136
    v_cmp_gt_u32 vcc, s62, v133
    v_sub_f32 v46, v46, v134
    s_nop 1
    v_cndmask_b32 v46, v135, v46, vcc
    v_exp_f32 v46, v46
    v_subrev_u32 v133, 23, v136
    v_cmp_gt_u32 vcc, s62, v133
    v_sub_f32 v47, v47, v134
    s_nop 1
    v_cndmask_b32 v47, v135, v47, vcc
    v_exp_f32 v47, v47
    s_nop 1
    v_smfmac_f32_32x32x32_bf16 v[160:175], v[144:147], v[32:39], v128
    v_smfmac_f32_32x32x32_bf16 v[160:175], v[148:151], v[40:47], v128
    s_add_u32 s17, s17, 1
    s_cmp_lt_u32 s17, 9
    s_cbranch_scc1 L_A_fb1
    s_branch L_A_fin
L_B_fb:
    s_waitcnt lgkmcnt(0)
    s_mov_b32 s8, 1
    s_mov_b32 s17, s14
    s_add_u32 s62, s14, 131072
    v_mov_b32 v134, s5
    v_and_b32 v132, 0x7ff, v132
L_B_fb_max:
    buffer_load_dwordx4 v[16:19], v14, s[36:39], s17 offen sc1
    s_add_u32 s17, s17, 2048
    s_waitcnt vmcnt(0)
    v_mfma_f32_32x32x16_bf16 v[32:47], v[16:19], v[116:119], 0
    s_nop 15
    v_max3_f32 v134, v32, v33, v134
    v_max3_f32 v134, v34, v35, v134
    v_max3_f32 v134, v36, v37, v134
    v_max3_f32 v134, v38, v39, v134
    v_max3_f32 v134, v40, v41, v134
    v_max3_f32 v134, v42, v43, v134
    v_max3_f32 v134, v44, v45, v134
    v_max3_f32 v134, v46, v47, v134
    s_cmp_lt_u32 s17, s62
    s_cbranch_scc1 L_B_fb_max
    v_mov_b32 v133, v134
    s_nop 1
    v_permlane32_swap_b32 v134, v133
    v_max_f32 v134, v134, v133
    v_mov_b32 v160, 0
    v_mov_b32 v161, 0
    v_mov_b32 v162, 0
    v_mov_b32 v163, 0
    v_mov_b32 v164, 0
    v_mov_b32 v165, 0
    v_mov_b32 v166, 0
    v_mov_b32 v167, 0
    v_mov_b32 v168, 0
    v_mov_b32 v169, 0
    v_mov_b32 v170, 0
    v_mov_b32 v171, 0
    v_mov_b32 v172, 0
    v_mov_b32 v173, 0
    v_mov_b32 v174, 0
    v_mov_b32 v175, 0
    s_mov_b32 s17, s14
L_B_fb_acc:
    buffer_load_dwordx4 v[16:19], v14, s[36:39], s17 offen sc1
    s_mov_b64 exec, s[22:23]
    buffer_load_dwordx4 v[144:147], v132, s[36:39], s17 offen sc1
    buffer_load_dwordx4 v[148:151], v132, s[36:39], s17 offen offset:512 sc1
    s_mov_b64 exec, -1
    s_add_u32 s17, s17, 2048
    s_waitcnt vmcnt(0)
    v_mfma_f32_32x32x16_bf16 v[32:47], v[16:19], v[116:119], 0
    s_nop 15
    v_sub_f32 v32, v32, v134
    v_sub_f32 v33, v33, v134
    v_sub_f32 v34, v34, v134
    v_sub_f32 v35, v35, v134
    v_sub_f32 v36, v36, v134
    v_sub_f32 v37, v37, v134
    v_sub_f32 v38, v38, v134
    v_sub_f32 v39, v39, v134
    v_sub_f32 v40, v40, v134
    v_sub_f32 v41, v41, v134
    v_sub_f32 v42, v42, v134
    v_sub_f32 v43, v43, v134
    v_sub_f32 v44, v44, v134
    v_sub_f32 v45, v45, v134
    v_sub_f32 v46, v46, v134
    v_sub_f32 v47, v47, v134
    v_exp_f32 v32, v32
    v_exp_f32 v33, v33
    v_exp_f32 v34, v34
    v_exp_f32 v35, v35
    v_exp_f32 v36, v36
    v_exp_f32 v37, v37
    v_exp_f32 v38, v38
    v_exp_f32 v39, v39
    v_exp_f32 v40, v40
    v_exp_f32 v41, v41
    v_exp_f32 v42, v42
    v_exp_f32 v43, v43
    v_exp_f32 v44, v44
    v_exp_f32 v45, v45
    v_exp_f32 v46, v46
    v_exp_f32 v47, v47
    s_nop 1
    v_smfmac_f32_32x32x32_bf16 v[160:175], v[144:147], v[32:39], v128
    v_smfmac_f32_32x32x32_bf16 v[160:175], v[148:151], v[40:47], v128
    s_cmp_lt_u32 s17, s62
    s_cbranch_scc1 L_B_fb_acc
    s_branch L_B_fin
L_code_end:
.section .rodata,"a"
.p2align 6
.amdhsa_kernel gated_mix__sliding_block__softmax_full_mha__prompt_kernel
  .amdhsa_next_free_vgpr 256
  .amdhsa_next_free_sgpr 74
  .amdhsa_accum_offset 256
  .amdhsa_group_segment_fixed_size 0
  .amdhsa_kernarg_size 80
  .amdhsa_user_sgpr_count 2
  .amdhsa_user_sgpr_kernarg_segment_ptr 1
  .amdhsa_system_sgpr_workgroup_id_x 1
.end_amdhsa_kernel
```
